```python
import torch

def _softmax(x, axis=-1):
    return torch.softmax(x, dim=axis)
def _gelu(x):
    return torch.nn.functional.gelu(x, approximate="tanh")
def _silu(x):
    return torch.nn.functional.silu(x)
def _sigmoid(x):
    return torch.sigmoid(x)
def _layernorm(x, axis=-1, eps=1e-5):
    m = x.mean(dim=axis, keepdim=True)
    v = x.var(dim=axis, keepdim=True, unbiased=False)
    return (x - m) / torch.sqrt(v + eps)
def _scatter_add(tgt, idx, src, axis=0):
    return tgt.clone().index_add_(axis, idx, src)
def _segment_sum(src, seg, n):
    out = torch.zeros((n,) + src.shape[1:], dtype=src.dtype)
    return out.index_add_(0, seg, src)
def _pad(x, pw):
    flat = tuple(v for pair in reversed(pw) for v in pair)
    return torch.nn.functional.pad(x, flat)

kernel_name = 'gather_scatter__edge_featured_mpnn_mpnn__graph'

def setup_inputs():

    _w = (lambda a: (lambda t: t.to(torch.bfloat16) if t.is_floating_point() else t)(torch.as_tensor(a)))
    N, deg, D, De = 25000, 16, 128, max(0, 1)
    E = N * deg
    H = 2 * D
    return {
        "x": _w((lambda *s: torch.randn(*s, dtype=torch.bfloat16) * 0.05)(N, D)),
        "e_attr": _w((lambda *s: torch.randn(*s, dtype=torch.bfloat16) * 1.6)(E, De)),
        "src": _w((lambda lo, hi, *s: torch.randint(lo, hi, s))(0, N, E).to(torch.int64)),
        "dst": _w((lambda lo, hi, *s: torch.randint(lo, hi, s))(0, N, E).to(torch.int64)),
        "w1": _w((lambda *s: torch.randn(*s, dtype=torch.bfloat16) * 1.6)(2 * D + De, H) * (1.0 / (2 * D + De) ** 0.5)),
        "b1": _w((lambda *s: torch.randn(*s, dtype=torch.bfloat16) * 1.6)(H) * 0.01),
        "w2": _w((lambda *s: torch.randn(*s, dtype=torch.bfloat16) * 0.05)(H, D) * (1.0 / H ** 0.5)),
        "b2": _w((lambda *s: torch.randn(*s, dtype=torch.bfloat16) * 0.05)(D) * 0.01),
    }

def reference(x, e_attr, src, dst, w1, b1, w2, b2):
    N, D = x.shape
    h_src = x[src]
    h_dst = x[dst]
    m_in = torch.concatenate([h_src, h_dst, e_attr], axis=-1)
    h = _silu(m_in @ w1 + b1)
    msg = h @ w2 + b2
    return _segment_sum(msg, dst, N)
```

```asm
; @launch grid=(256,1,1) block=(1024,1,1) lds=163840
.amdgcn_target "amdgcn-amd-amdhsa--gfx950"
.text
.globl gather_scatter__edge_featured_mpnn_mpnn__graph_kernel
.p2align 8
.type gather_scatter__edge_featured_mpnn_mpnn__graph_kernel,@function
gather_scatter__edge_featured_mpnn_mpnn__graph_kernel:
    s_cmp_ge_u32 s2, 256
    s_cbranch_scc1 main_done
    s_load_dwordx8 s[40:47], s[0:1], 0
    s_load_dwordx4 s[52:55], s[0:1], 32
    v_lshrrev_b32 v120, 6, v0
    v_mov_b32 v112, v0
    v_readfirstlane_b32 s25, v120
    s_load_dwordx2 s[66:67], s[0:1], 48
    s_load_dwordx4 s[56:59], s[0:1], 56
    s_load_dwordx4 s[60:63], s[0:1], 72
    v_and_b32 v113, 63, v0
    s_cmp_lg_u32 s25, 8
    s_cbranch_scc1 cleared
    v_mov_b32 v4, 0
    v_mov_b32 v5, 0
    v_mov_b32 v6, 0
    v_mov_b32 v7, 0
    v_lshlrev_b32 v8, 4, v113
    ds_write_b128 v8, v[4:7] offset:0
    ds_write_b128 v4, v[4:7] offset:23520
    ds_write_b64 v4, v[4:5] offset:23584
    s_waitcnt lgkmcnt(0)
cleared:
    s_barrier
    s_and_b32 s24, s2, 7
    s_lshl_b32 s24, s24, 5
    s_lshr_b32 s48, s2, 3
    s_add_u32 s24, s24, s48
    s_mov_b32 s26, 0
    s_mov_b32 s27, 2048
    s_mov_b32 s3, 0
    s_mov_b32 s71, 0
    s_cmp_ge_u32 s25, 8
    s_cbranch_scc1 helper
    v_lshlrev_b32 v30, 4, v0
    v_lshlrev_b32 v31, 3, v0
    s_mul_i32 s48, s2, 6400
    s_mul_i32 s49, s2, 3200
    s_cmp_lt_u32 s2, 250
    s_cselect_b32 s50, 400, 0
    v_cmp_gt_u32 s[68:69], s50, v112
    s_waitcnt lgkmcnt(0)
    s_mov_b32 s8, s46
    s_and_b32 s9, s47, 0xffff
    s_mov_b32 s10, 0x186a00
    s_mov_b32 s11, 0x20000
    buffer_load_dwordx4 v[0:3], v30, s[8:11], s48 offen
    s_mov_b32 s8, s44
    s_and_b32 s9, s45, 0xffff
    s_mov_b32 s10, 0x186a00
    s_mov_b32 s11, 0x20000
    s_mov_b32 s20, s42
    s_and_b32 s21, s43, 0xffff
    s_mov_b32 s22, 0xc3500
    s_mov_b32 s23, 0x20000
    buffer_load_dwordx4 v[4:7], v30, s[8:11], s48 offen
    buffer_load_dwordx2 v[8:9], v31, s[20:23], s49 offen
    s_mov_b32 s12, s62
    s_and_b32 s13, s63, 0xffff
    s_mov_b32 s14, 0x5000000
    s_mov_b32 s15, 0x20000
    s_mov_b32 s72, s60
    s_and_b32 s73, s61, 0xffff
    s_mov_b32 s74, 0x100
    s_mov_b32 s75, 0x20000
    s_add_u32 s4, s62, 0x400000
    s_addc_u32 s5, s63, 0
    s_and_b32 s5, s5, 0xffff
    s_mov_b32 s6, 0xc35200
    s_mov_b32 s7, 0x20000
    s_mov_b32 s16, s58
    s_and_b32 s17, s59, 0xffff
    s_mov_b32 s18, 0x61a800
    s_mov_b32 s19, 0x20000
    s_add_u32 s76, s62, 0x3ffd00
    s_addc_u32 s77, s63, 0
    s_and_b32 s77, s77, 0xffff
    s_or_b32 s77, s77, 0x100000
    s_mov_b32 s78, 64
    s_mov_b32 s79, 0x800000
    s_cmp_lg_u32 s25, 0
    s_cbranch_scc1 no_go_a
    v_lshlrev_b32 v126, 2, v113
    s_lshr_b32 s48, s2, 3
    s_lshl_b32 s48, s48, 7
    s_add_u32 s48, s48, 0x3c0000
    v_mov_b32 v50, 0
    s_mov_b64 exec, 0xfff
    buffer_atomic_add v50, v126, s[12:15], s48 offen sc0 sc1
    s_mov_b64 exec, -1
no_go_a:
    v_mov_b32 v33, 1
    s_mov_b64 exec, s[68:69]
    s_waitcnt vmcnt(2)
    v_mul_u32_u24 v10, 42800, v0
    v_lshrrev_b32 v10, 22, v10
    v_mul_u32_u24 v14, 98, v10
    v_lshlrev_b32 v10, 2, v10
    v_sub_u32 v14, v0, v14
    ds_add_rtn_u32 v18, v10, v33 offset:0
    v_mul_u32_u24 v11, 42800, v1
    v_lshrrev_b32 v11, 22, v11
    v_mul_u32_u24 v15, 98, v11
    v_lshlrev_b32 v11, 2, v11
    v_sub_u32 v15, v1, v15
    ds_add_rtn_u32 v19, v11, v33 offset:0
    v_mul_u32_u24 v12, 42800, v2
    v_lshrrev_b32 v12, 22, v12
    v_mul_u32_u24 v16, 98, v12
    v_lshlrev_b32 v12, 2, v12
    v_sub_u32 v16, v2, v16
    ds_add_rtn_u32 v20, v12, v33 offset:0
    v_mul_u32_u24 v13, 42800, v3
    v_lshrrev_b32 v13, 22, v13
    v_mul_u32_u24 v17, 98, v13
    v_lshlrev_b32 v13, 2, v13
    v_sub_u32 v17, v3, v17
    ds_add_rtn_u32 v21, v13, v33 offset:0
    s_waitcnt vmcnt(0)
    v_lshl_or_b32 v22, v4, 9, v14
    v_lshlrev_b32 v23, 16, v8
    v_lshl_or_b32 v24, v5, 9, v15
    v_and_b32 v25, 0xffff0000, v8
    v_lshl_or_b32 v26, v6, 9, v16
    v_lshlrev_b32 v27, 16, v9
    v_lshl_or_b32 v28, v7, 9, v17
    v_and_b32 v29, 0xffff0000, v9
    s_mov_b64 exec, -1
    s_cmp_lg_u32 s25, 0
    s_cbranch_scc1 no_keep
    v_lshlrev_b32 v126, 2, v113
    s_mov_b64 exec, 0xfff
    ds_write_b32 v126, v50 offset:23536
    s_mov_b64 exec, -1
no_keep:
    s_waitcnt lgkmcnt(0)
    s_add_u32 s3, s3, 8
    s_mov_b64 exec, 1
    v_mov_b32 v126, 23520
    v_mov_b32 v127, 1
    ds_add_u32 v126, v127
    s_mov_b32 s70, 0x4000000
sw_c1:
    ds_read_b32 v127, v126
    s_sub_u32 s70, s70, 1
    s_cbranch_scc1 sw_out_c1
    s_waitcnt lgkmcnt(0)
    v_cmp_gt_u32 vcc, s3, v127
    s_cbranch_vccz sw_out_c1
    s_sleep 1
    s_branch sw_c1
sw_out_c1:
    s_waitcnt lgkmcnt(0)
    s_mov_b64 exec, -1
    s_cmp_lg_u32 s25, 7
    s_cbranch_scc1 no_scan
    v_lshlrev_b32 v32, 4, v113
    ds_read_b128 v[36:39], v32 offset:0
    s_lshl_b32 s48, s2, 2
    s_add_u32 s48, s48, 0x320000
    v_lshlrev_b32 v33, 12, v113
    s_waitcnt lgkmcnt(0)
    v_add_u32 v41, v36, v37
    v_add_u32 v42, v41, v38
    v_add_u32 v43, v42, v39
    v_mov_b32 v44, v43
    s_nop 1
    v_add_u32_dpp v44, v44, v44 row_shr:1 row_mask:0xf bank_mask:0xf
    s_nop 1
    v_add_u32_dpp v44, v44, v44 row_shr:2 row_mask:0xf bank_mask:0xf
    s_nop 1
    v_add_u32_dpp v44, v44, v44 row_shr:4 row_mask:0xf bank_mask:0xf
    s_nop 1
    v_add_u32_dpp v44, v44, v44 row_shr:8 row_mask:0xf bank_mask:0xf
    s_nop 1
    v_add_u32_dpp v44, v44, v44 row_bcast:15 row_mask:0xa bank_mask:0xf
    s_nop 1
    v_add_u32_dpp v44, v44, v44 row_bcast:31 row_mask:0xc bank_mask:0xf
    v_sub_u32 v40, v44, v43
    v_add_u32 v43, v40, v42
    v_add_u32 v42, v40, v41
    v_add_u32 v41, v40, v36
    ds_write_b128 v32, v[40:43] offset:0
    s_cmp_lg_u32 s2, 64
    s_cbranch_scc1 no_sink
    v_mov_b32 v4, 0xb180cb80
    v_mov_b32 v5, 0xb180cb80
    v_mov_b32 v6, 0xb180cb80
    v_mov_b32 v7, 0xb180cb80
    s_mov_b32 s49, 0x1035000
    s_mov_b32 exec_hi, 0
    buffer_store_dwordx4 v[4:7], v32, s[12:15], s49 offen sc1
    s_mov_b64 exec, -1
no_sink:
    s_cmp_ge_u32 s2, 250
    s_cbranch_scc1 no_scan
    v_lshl_or_b32 v36, v36, 16, v40
    buffer_store_dword v36, v33, s[12:15], s48 offen offset:0 sc1
    v_lshl_or_b32 v37, v37, 16, v41
    buffer_store_dword v37, v33, s[12:15], s48 offen offset:1024 sc1
    v_lshl_or_b32 v38, v38, 16, v42
    buffer_store_dword v38, v33, s[12:15], s48 offen offset:2048 sc1
    v_lshl_or_b32 v39, v39, 16, v43
    buffer_store_dword v39, v33, s[12:15], s48 offen offset:3072 sc1
no_scan:
    s_waitcnt lgkmcnt(0)
    s_add_u32 s3, s3, 8
    s_mov_b64 exec, 1
    v_mov_b32 v126, 23520
    v_mov_b32 v127, 1
    ds_add_u32 v126, v127
    s_mov_b32 s70, 0x4000000
sw_c2:
    ds_read_b32 v127, v126
    s_sub_u32 s70, s70, 1
    s_cbranch_scc1 sw_out_c2
    s_waitcnt lgkmcnt(0)
    v_cmp_gt_u32 vcc, s3, v127
    s_cbranch_vccz sw_out_c2
    s_sleep 1
    s_branch sw_c2
sw_out_c2:
    s_waitcnt lgkmcnt(0)
    s_mov_b64 exec, -1
    s_mov_b64 exec, s[68:69]
    ds_read_b32 v10, v10 offset:0
    ds_read_b32 v11, v11 offset:0
    ds_read_b32 v12, v12 offset:0
    ds_read_b32 v13, v13 offset:0
    s_waitcnt lgkmcnt(0)
    v_add_lshl_u32 v10, v10, v18, 3
    ds_write_b64 v10, v[22:23] offset:1024
    v_add_lshl_u32 v11, v11, v19, 3
    ds_write_b64 v11, v[24:25] offset:1024
    v_add_lshl_u32 v12, v12, v20, 3
    ds_write_b64 v12, v[26:27] offset:1024
    v_add_lshl_u32 v13, v13, v21, 3
    ds_write_b64 v13, v[28:29] offset:1024
    s_waitcnt lgkmcnt(0)
    s_add_u32 s3, s3, 8
    s_mov_b64 exec, 1
    v_mov_b32 v126, 23520
    v_mov_b32 v127, 1
    ds_add_u32 v126, v127
    s_mov_b32 s70, 0x4000000
sw_c3:
    ds_read_b32 v127, v126
    s_sub_u32 s70, s70, 1
    s_cbranch_scc1 sw_out_c3
    s_waitcnt lgkmcnt(0)
    v_cmp_gt_u32 vcc, s3, v127
    s_cbranch_vccz sw_out_c3
    s_sleep 1
    s_branch sw_c3
sw_out_c3:
    s_waitcnt lgkmcnt(0)
    s_mov_b64 exec, -1
    s_cmp_ge_u32 s2, 250
    s_cbranch_scc1 copied
    ds_read_b128 v[0:3], v30 offset:1024
    ds_read_b128 v[4:7], v30 offset:9216
    s_mul_i32 s48, s2, 12800
    v_add_u32 v32, 8192, v30
    s_waitcnt lgkmcnt(1)
    buffer_store_dwordx4 v[0:3], v30, s[12:15], s48 offen sc1
    v_cmpx_gt_u32 vcc, 4608, v30
    s_cbranch_execz copied
    s_waitcnt lgkmcnt(0)
    buffer_store_dwordx4 v[4:7], v32, s[12:15], s48 offen sc1
copied:
    s_mov_b64 exec, -1
    s_getpc_b64 s[20:21]
pc_here_c:
    s_add_u32 s20, s20, lut_jobs - pc_here_c
    s_addc_u32 s21, s21, 0
    s_lshl_b32 s49, s25, 3
    s_load_dwordx2 s[64:65], s[20:21], s49
    s_mov_b32 s38, 0x3f80
    s_mov_b32 s32, 0x3f800000
    s_mov_b32 s39, 76800
    s_mov_b32 s40, 0x20000000
    s_mov_b32 s41, 0x20000000
    s_mov_b32 s42, 0x3f800000
    s_mov_b32 s43, 0x3f800000
    s_mov_b32 s44, 0x1fb17218
    s_mov_b32 s45, 0x1fb17218
    s_mov_b32 s46, 0x3f800000
    s_mov_b32 s47, 0x3f800000
    v_mov_b32 v118, 21312
    v_and_b32 v104, 15, v113
    v_lshrrev_b32 v116, 4, v113
    v_lshlrev_b32 v115, 5, v104
    v_add_u32 v115, 18496, v115
    v_lshlrev_b32 v105, 3, v116
    v_lshlrev_b32 v104, 4, v104
    v_lshlrev_b32 v116, 2, v116
    v_add_u32 v116, 22368, v116
    s_waitcnt vmcnt(0) lgkmcnt(0)
    s_add_u32 s3, s3, 8
    s_mov_b64 exec, 1
    v_mov_b32 v126, 23520
    v_mov_b32 v127, 1
    ds_add_u32 v126, v127
    s_mov_b32 s70, 0x4000000
sw_c4:
    ds_read_b32 v127, v126
    s_sub_u32 s70, s70, 1
    s_cbranch_scc1 sw_out_c4
    s_waitcnt lgkmcnt(0)
    v_cmp_gt_u32 vcc, s3, v127
    s_cbranch_vccz sw_out_c4
    s_sleep 1
    s_branch sw_c4
sw_out_c4:
    s_waitcnt lgkmcnt(0)
    s_mov_b64 exec, -1
    s_cmp_lg_u32 s25, 0
    s_cbranch_scc1 not_w0
    s_and_b32 s48, s2, 3
    s_lshl_b32 s49, s48, 6
    s_mov_b64 exec, 1
    v_mov_b32 v127, 1
    v_mov_b32 v126, s49
    buffer_atomic_add v127, v126, s[72:75], 0 offen offset:0 sc0 sc1
    s_mov_b64 exec, -1
    s_lshl_b32 s48, s48, 2
    s_add_u32 s48, s48, 0x3c0000
    s_waitcnt vmcnt(0)
    v_readfirstlane_b32 s49, v127
    v_lshlrev_b32 v126, 7, v113
    v_mov_b32 v127, 1
    s_and_b32 s49, s49, 63
    s_cmp_lg_u32 s49, 63
    s_cbranch_scc1 pub_done_0
    s_mov_b32 exec_hi, 0
    buffer_atomic_add v127, v126, s[12:15], s48 offen sc1
    s_mov_b64 exec, -1
pub_done_0:
not_w0:
    s_cmp_eq_u32 s25, 2
    s_cbranch_scc1 cb_tables
    s_cmp_eq_u32 s25, 3
    s_cbranch_scc1 frag_w2
    s_cmp_lg_u32 s25, 1
    s_cbranch_scc1 chain_init
    v_lshlrev_b32 v121, 3, v113
    v_mov_b32 v122, 0
    v_mov_b32 v123, 0
    ds_write_b64 v121, v[122:123] offset:21344
chain_init:
    v_lshlrev_b32 v120, 4, v112
    v_and_b32 v64, 1, v112
    v_lshlrev_b32 v64, 9, v64
    v_sub_u32 v64, 0xc35300, v64
    v_mov_b32 v65, 0
    v_subrev_u32 v66, 256, v64
    v_mov_b32 v67, 0
    ds_write_b128 v120, v[64:67] offset:128
    ds_write_b128 v120, v[64:67] offset:8320
    s_cmp_ge_u32 s25, 3
    s_cbranch_scc1 init_done
    v_cmpx_gt_u32 vcc, 124, v112
    ds_write_b128 v120, v[64:67] offset:16512
    v_cmpx_gt_u32 vcc, 50, v112
    v_mov_b32 v64, 0
    v_mov_b32 v66, 0
    ds_write_b128 v120, v[64:67] offset:20544
    s_mov_b64 exec, -1
init_done:
    s_cmp_lg_u32 s26, 0
    s_cbranch_scc1 no_wait_a
    s_cmp_lg_u32 s27, 2048
    s_cbranch_scc1 no_wait_a
    s_cmp_eq_u32 s25, 0
    s_cbranch_scc1 wait_a
    s_mov_b64 exec, 1
    v_mov_b32 v126, 23528
    s_mov_b32 s70, 0x4000000
lw_wa:
    ds_read_b32 v127, v126
    s_sub_u32 s70, s70, 1
    s_cbranch_scc1 lw_out_wa
    s_waitcnt lgkmcnt(0)
    v_cmp_gt_u32 vcc, 8, v127
    s_cbranch_vccz lw_out_wa
    s_sleep 2
    s_branch lw_wa
lw_out_wa:
    s_waitcnt lgkmcnt(0)
    s_mov_b64 exec, -1
    s_mov_b64 s[22:23], s[64:65]
lut_job_c:
    s_bfe_u32 s50, s22, 0x50007
    s_cmp_eq_u32 s50, 0
    s_cbranch_scc1 lut_done_c
    s_and_b32 s51, s22, 0x7f
    s_lshl_b32 s48, s51, 25
    s_or_b32 s48, s48, 0x8000
    v_lshl_add_u32 v72, v113, 19, s48
    s_lshl_b32 s49, s51, 10
    s_add_u32 s49, s49, 76800
    v_lshl_add_u32 v80, v113, 4, s49
    v_add_u32 v73, 0x10000, v72
    v_add_u32 v74, 0x20000, v72
    v_add_u32 v75, 0x30000, v72
    v_add_u32 v76, 0x40000, v72
    v_add_u32 v77, 0x50000, v72
    v_add_u32 v78, 0x60000, v72
    v_add_u32 v79, 0x70000, v72
    s_and_b32 s48, s51, 63
    s_sub_u32 s48, s48, 16
    s_cmp_lt_u32 s48, 5
    s_cbranch_scc1 lut_full_c
    s_mov_b32 s49, 0x59317218
    s_cmp_lt_i32 s48, 0
    s_cselect_b32 s48, 0x58b17218, s49
    s_mov_b32 s49, s48
    v_pk_mul_f32 v[72:73], v[72:73], s[48:49]
    v_pk_mul_f32 v[74:75], v[74:75], s[48:49]
    v_pk_mul_f32 v[76:77], v[76:77], s[48:49]
    v_pk_mul_f32 v[78:79], v[78:79], s[48:49]
    s_branch lut_pack_c
lut_full_c:
    s_mov_b32 s48, 0x59800000
    s_mov_b32 s49, s48
    v_pk_mul_f32 v[72:73], v[72:73], s[48:49]
    v_pk_mul_f32 v[74:75], v[74:75], s[48:49]
    v_pk_mul_f32 v[76:77], v[76:77], s[48:49]
    v_pk_mul_f32 v[78:79], v[78:79], s[48:49]
    s_mov_b32 s48, 0x3f317218
    s_mov_b32 s49, s48
    v_exp_f32 v88, -v72
    v_exp_f32 v89, -v73
    v_exp_f32 v90, -v74
    v_exp_f32 v91, -v75
    v_exp_f32 v92, -v76
    v_exp_f32 v93, -v77
    v_exp_f32 v94, -v78
    v_exp_f32 v95, -v79
    v_pk_mul_f32 v[72:73], v[72:73], s[48:49]
    v_pk_add_f32 v[88:89], v[88:89], s[42:43]
    v_pk_mul_f32 v[74:75], v[74:75], s[48:49]
    v_pk_add_f32 v[90:91], v[90:91], s[42:43]
    v_pk_mul_f32 v[76:77], v[76:77], s[48:49]
    v_pk_add_f32 v[92:93], v[92:93], s[42:43]
    v_pk_mul_f32 v[78:79], v[78:79], s[48:49]
    v_pk_add_f32 v[94:95], v[94:95], s[42:43]
    v_rcp_f32 v88, v88
    v_rcp_f32 v89, v89
    v_rcp_f32 v90, v90
    v_rcp_f32 v91, v91
    v_rcp_f32 v92, v92
    v_rcp_f32 v93, v93
    v_rcp_f32 v94, v94
    v_rcp_f32 v95, v95
    v_pk_mul_f32 v[72:73], v[72:73], v[88:89]
    v_pk_mul_f32 v[74:75], v[74:75], v[90:91]
    v_pk_mul_f32 v[76:77], v[76:77], v[92:93]
    v_pk_mul_f32 v[78:79], v[78:79], v[94:95]
lut_pack_c:
    v_cvt_pk_bf16_f32 v82, v72, v73
    v_cvt_pk_bf16_f32 v83, v74, v75
    v_cvt_pk_bf16_f32 v84, v76, v77
    v_cvt_pk_bf16_f32 v85, v78, v79
    s_bitcmp1_b32 s22, 12
    s_cselect_b32 s48, 0x02000200, 0
    ds_write_b128 v80, v[82:85] offset:0
    s_cmp_eq_u32 s50, 1
    s_cbranch_scc1 lut_next_c
    v_add_u32 v86, s48, v82
    v_add_u32 v87, s48, v83
    v_add_u32 v88, s48, v84
    v_add_u32 v89, s48, v85
    ds_write_b128 v80, v[86:89] offset:1024
    s_cmp_eq_u32 s50, 2
    s_cbranch_scc1 lut_next_c
    v_add_u32 v82, s48, v86
    v_add_u32 v83, s48, v87
    v_add_u32 v84, s48, v88
    v_add_u32 v85, s48, v89
    ds_write_b128 v80, v[82:85] offset:2048
    s_cmp_eq_u32 s50, 3
    s_cbranch_scc1 lut_next_c
    v_add_u32 v86, s48, v82
    v_add_u32 v87, s48, v83
    v_add_u32 v88, s48, v84
    v_add_u32 v89, s48, v85
    ds_write_b128 v80, v[86:89] offset:3072
    s_cmp_eq_u32 s50, 4
    s_cbranch_scc1 lut_next_c
    v_add_u32 v82, s48, v86
    v_add_u32 v83, s48, v87
    v_add_u32 v84, s48, v88
    v_add_u32 v85, s48, v89
    ds_write_b128 v80, v[82:85] offset:4096
    s_cmp_eq_u32 s50, 5
    s_cbranch_scc1 lut_next_c
    v_add_u32 v86, s48, v82
    v_add_u32 v87, s48, v83
    v_add_u32 v88, s48, v84
    v_add_u32 v89, s48, v85
    ds_write_b128 v80, v[86:89] offset:5120
    s_cmp_eq_u32 s50, 6
    s_cbranch_scc1 lut_next_c
    v_add_u32 v82, s48, v86
    v_add_u32 v83, s48, v87
    v_add_u32 v84, s48, v88
    v_add_u32 v85, s48, v89
    ds_write_b128 v80, v[82:85] offset:6144
    s_cmp_eq_u32 s50, 7
    s_cbranch_scc1 lut_next_c
    v_add_u32 v86, s48, v82
    v_add_u32 v87, s48, v83
    v_add_u32 v88, s48, v84
    v_add_u32 v89, s48, v85
    ds_write_b128 v80, v[86:89] offset:7168
    s_cmp_eq_u32 s50, 8
    s_cbranch_scc1 lut_next_c
    v_add_u32 v82, s48, v86
    v_add_u32 v83, s48, v87
    v_add_u32 v84, s48, v88
    v_add_u32 v85, s48, v89
    ds_write_b128 v80, v[82:85] offset:8192
    s_cmp_eq_u32 s50, 9
    s_cbranch_scc1 lut_next_c
    v_add_u32 v86, s48, v82
    v_add_u32 v87, s48, v83
    v_add_u32 v88, s48, v84
    v_add_u32 v89, s48, v85
    ds_write_b128 v80, v[86:89] offset:9216
    s_cmp_eq_u32 s50, 10
    s_cbranch_scc1 lut_next_c
    v_add_u32 v82, s48, v86
    v_add_u32 v83, s48, v87
    v_add_u32 v84, s48, v88
    v_add_u32 v85, s48, v89
    ds_write_b128 v80, v[82:85] offset:10240
    s_cmp_eq_u32 s50, 11
    s_cbranch_scc1 lut_next_c
    v_add_u32 v86, s48, v82
    v_add_u32 v87, s48, v83
    v_add_u32 v88, s48, v84
    v_add_u32 v89, s48, v85
    ds_write_b128 v80, v[86:89] offset:11264
lut_next_c:
    s_lshr_b64 s[22:23], s[22:23], 16
    s_branch lut_job_c
lut_done_c:
    s_branch no_wait_a
wait_a:
    v_lshlrev_b32 v126, 2, v113
    s_lshr_b32 s48, s2, 3
    s_lshl_b32 s48, s48, 7
    s_add_u32 s48, s48, 0x3c0000
    s_mov_b32 s49, 0x40000
    s_mov_b64 exec, 15
    ds_read_b32 v119, v126 offset:23536
aw_0:
    v_mov_b32 v127, 0
    buffer_atomic_add v127, v126, s[12:15], s48 offen sc0 sc1
    s_sub_u32 s49, s49, 1
    s_cbranch_scc1 aw_done_0
    s_waitcnt vmcnt(0) lgkmcnt(0)
    v_cmp_eq_u32 vcc, v119, v127
    s_cbranch_vccz aw_done_0
    s_sleep 4
    s_branch aw_0
aw_done_0:
    s_waitcnt vmcnt(0) lgkmcnt(0)
    s_mov_b64 exec, -1
no_wait_a:
    s_waitcnt lgkmcnt(0)
    s_add_u32 s3, s3, 8
    s_mov_b64 exec, 1
    v_mov_b32 v126, 23520
    v_mov_b32 v127, 1
    ds_add_u32 v126, v127
    s_mov_b32 s70, 0x4000000
sw_c5:
    ds_read_b32 v127, v126
    s_sub_u32 s70, s70, 1
    s_cbranch_scc1 sw_out_c5
    s_waitcnt lgkmcnt(0)
    v_cmp_gt_u32 vcc, s3, v127
    s_cbranch_vccz sw_out_c5
    s_sleep 3
    s_branch sw_c5
sw_out_c5:
    s_waitcnt lgkmcnt(0)
    s_mov_b64 exec, -1
    s_cmp_lg_u32 s26, 0
    s_cbranch_scc1 have_table
    s_cmp_lg_u32 s27, 2048
    s_cbranch_scc1 have_table
    v_and_b32 v120, -4, v112
    s_lshl_b32 s48, s24, 10
    s_add_u32 s48, s48, 0x320000
    buffer_load_dword v110, v120, s[12:15], s48 offen sc1
    buffer_load_dword v114, v120, s[12:15], s48 offen offset:512 sc1
    v_cmp_gt_u32 vcc, 488, v112
    s_waitcnt vmcnt(0)
    v_lshrrev_b32 v117, 16, v114
    v_lshrrev_b32 v111, 16, v110
    v_and_b32 v110, 0xffff, v110
    v_and_b32 v114, 0xffff, v114
    v_cndmask_b32 v117, 0, v117, vcc
have_table:
    v_lshrrev_b32 v120, 2, v112
    v_and_b32 v62, 3, v112
    v_mul_u32_u24 v120, 12800, v120
    v_lshl_add_u32 v120, v62, 4, v120
    v_lshlrev_b32 v62, 1, v62
    v_min_u32 v56, 24, v111
    v_lshl_add_u32 v60, v110, 3, v120
    v_sub_u32 v58, v56, v62 clamp
    v_min_u32 v57, 24, v117
    v_lshl_add_u32 v61, v114, 3, v120
    v_sub_u32 v59, v57, v62 clamp
    s_mov_b32 s48, 1638400
    v_cmp_lt_u32 vcc, 0, v58
    s_mov_b64 exec, vcc
    s_cbranch_execz rec_skip_00
    buffer_load_dwordx4 v[0:3], v60, s[12:15], 0 offen offset:0 sc1
rec_skip_00:
    s_mov_b64 exec, -1
    v_cmp_lt_u32 vcc, 0, v59
    s_mov_b64 exec, vcc
    s_cbranch_execz rec_skip_01
    buffer_load_dwordx4 v[12:15], v61, s[12:15], s48 offen offset:0 sc1
rec_skip_01:
    s_mov_b64 exec, -1
    v_cmp_lt_u32 vcc, 8, v58
    s_mov_b64 exec, vcc
    s_cbranch_execz rec_skip_10
    buffer_load_dwordx4 v[4:7], v60, s[12:15], 0 offen offset:64 sc1
rec_skip_10:
    s_mov_b64 exec, -1
    v_cmp_lt_u32 vcc, 8, v59
    s_mov_b64 exec, vcc
    s_cbranch_execz rec_skip_11
    buffer_load_dwordx4 v[16:19], v61, s[12:15], s48 offen offset:64 sc1
rec_skip_11:
    s_mov_b64 exec, -1
    v_cmp_lt_u32 vcc, 16, v58
    s_mov_b64 exec, vcc
    s_cbranch_execz rec_skip_20
    buffer_load_dwordx4 v[8:11], v60, s[12:15], 0 offen offset:128 sc1
rec_skip_20:
    s_mov_b64 exec, -1
    v_cmp_lt_u32 vcc, 16, v59
    s_mov_b64 exec, vcc
    s_cbranch_execz rec_skip_21
    buffer_load_dwordx4 v[20:23], v61, s[12:15], s48 offen offset:128 sc1
rec_skip_21:
    s_mov_b64 exec, -1
    v_mov_b32 v125, 1
    s_cmp_eq_u32 s27, 2048
    s_cbranch_scc1 admitted
    v_cmpx_eq_u32 vcc, 0, v62
    ds_add_rtn_u32 v120, v118, v56
    ds_add_rtn_u32 v121, v118, v57
    s_mov_b64 exec, -1
    v_mov_b32 v123, s27
    s_waitcnt lgkmcnt(0)
    s_nop 2
    v_mov_b32_dpp v120, v120 quad_perm:[0,0,0,0] row_mask:0xf bank_mask:0xf
    v_sub_u32 v120, v123, v120 clamp
    v_min_u32 v56, v56, v120
    v_sub_u32 v58, v56, v62 clamp
    v_mov_b32_dpp v121, v121 quad_perm:[0,0,0,0] row_mask:0xf bank_mask:0xf
    v_sub_u32 v121, v123, v121 clamp
    v_min_u32 v57, v57, v121
    v_sub_u32 v59, v57, v62 clamp
admitted:
    v_cmp_lt_u32 vcc, v56, v111
    v_cmp_lt_u32 s[20:21], v57, v117
    s_or_b64 exec, vcc, s[20:21]
    s_cbranch_execz no_more
    ds_write_b32 v118, v125 offset:4
no_more:
    s_mov_b64 exec, -1
    v_max_u32 v123, v58, v59
    v_cmp_lt_u32 s[68:69], 16, v123
    s_waitcnt vmcnt(0)
    v_cmpx_lt_u32 vcc, 0, v58
    v_and_b32 v24, 0x7f, v0
    v_lshlrev_b32 v24, 2, v24
    v_and_b32 v0, 0xfffffe00, v0
    v_min_u32 v0, 0xc35000, v0
    ds_add_rtn_u32 v36, v24, v125 offset:20544
    v_cmpx_lt_u32 vcc, 1, v58
    v_and_b32 v25, 0x7f, v2
    v_lshlrev_b32 v25, 2, v25
    v_and_b32 v2, 0xfffffe00, v2
    v_min_u32 v2, 0xc35000, v2
    ds_add_rtn_u32 v37, v25, v125 offset:20544
    s_mov_b64 exec, -1
    v_cmpx_lt_u32 vcc, 0, v59
    v_and_b32 v26, 0x7f, v12
    v_lshlrev_b32 v26, 2, v26
    v_and_b32 v12, 0xfffffe00, v12
    v_min_u32 v12, 0xc35000, v12
    ds_add_rtn_u32 v38, v26, v125 offset:20544
    v_cmpx_lt_u32 vcc, 1, v59
    v_and_b32 v27, 0x7f, v14
    v_lshlrev_b32 v27, 2, v27
    v_and_b32 v14, 0xfffffe00, v14
    v_min_u32 v14, 0xc35000, v14
    ds_add_rtn_u32 v39, v27, v125 offset:20544
    s_mov_b64 exec, -1
    v_cmpx_lt_u32 vcc, 8, v58
    v_and_b32 v28, 0x7f, v4
    v_lshlrev_b32 v28, 2, v28
    v_and_b32 v4, 0xfffffe00, v4
    v_min_u32 v4, 0xc35000, v4
    ds_add_rtn_u32 v40, v28, v125 offset:20544
    v_cmpx_lt_u32 vcc, 9, v58
    v_and_b32 v29, 0x7f, v6
    v_lshlrev_b32 v29, 2, v29
    v_and_b32 v6, 0xfffffe00, v6
    v_min_u32 v6, 0xc35000, v6
    ds_add_rtn_u32 v41, v29, v125 offset:20544
    s_mov_b64 exec, -1
    v_cmpx_lt_u32 vcc, 8, v59
    v_and_b32 v30, 0x7f, v16
    v_lshlrev_b32 v30, 2, v30
    v_and_b32 v16, 0xfffffe00, v16
    v_min_u32 v16, 0xc35000, v16
    ds_add_rtn_u32 v42, v30, v125 offset:20544
    v_cmpx_lt_u32 vcc, 9, v59
    v_and_b32 v31, 0x7f, v18
    v_lshlrev_b32 v31, 2, v31
    v_and_b32 v18, 0xfffffe00, v18
    v_min_u32 v18, 0xc35000, v18
    ds_add_rtn_u32 v43, v31, v125 offset:20544
    s_cmp_eq_u64 s[68:69], 0
    s_cbranch_scc1 ranked
    s_mov_b64 exec, -1
    v_cmpx_lt_u32 vcc, 16, v58
    v_and_b32 v32, 0x7f, v8
    v_lshlrev_b32 v32, 2, v32
    v_and_b32 v8, 0xfffffe00, v8
    v_min_u32 v8, 0xc35000, v8
    ds_add_rtn_u32 v44, v32, v125 offset:20544
    v_cmpx_lt_u32 vcc, 17, v58
    v_and_b32 v33, 0x7f, v10
    v_lshlrev_b32 v33, 2, v33
    v_and_b32 v10, 0xfffffe00, v10
    v_min_u32 v10, 0xc35000, v10
    ds_add_rtn_u32 v45, v33, v125 offset:20544
    s_mov_b64 exec, -1
    v_cmpx_lt_u32 vcc, 16, v59
    v_and_b32 v34, 0x7f, v20
    v_lshlrev_b32 v34, 2, v34
    v_and_b32 v20, 0xfffffe00, v20
    v_min_u32 v20, 0xc35000, v20
    ds_add_rtn_u32 v46, v34, v125 offset:20544
    v_cmpx_lt_u32 vcc, 17, v59
    v_and_b32 v35, 0x7f, v22
    v_lshlrev_b32 v35, 2, v35
    v_and_b32 v22, 0xfffffe00, v22
    v_min_u32 v22, 0xc35000, v22
    ds_add_rtn_u32 v47, v35, v125 offset:20544
ranked:
    s_waitcnt lgkmcnt(0)
    s_add_u32 s3, s3, 8
    s_mov_b64 exec, 1
    v_mov_b32 v126, 23520
    v_mov_b32 v127, 1
    ds_add_u32 v126, v127
    s_mov_b32 s70, 0x4000000
sw_c6:
    ds_read_b32 v127, v126
    s_sub_u32 s70, s70, 1
    s_cbranch_scc1 sw_out_c6
    s_waitcnt lgkmcnt(0)
    v_cmp_gt_u32 vcc, s3, v127
    s_cbranch_vccz sw_out_c6
    s_sleep 1
    s_branch sw_c6
sw_out_c6:
    s_waitcnt lgkmcnt(0)
    s_mov_b64 exec, -1
    s_cmp_eq_u32 s25, 0
    s_cbranch_scc1 sorter
    s_cmp_gt_u32 s25, 4
    s_cbranch_scc1 sorted
    v_lshlrev_b32 v126, 2, v113
    s_lshr_b32 s48, s2, 3
    s_lshl_b32 s48, s48, 7
    s_add_u32 s48, s48, 0x3c0010
    s_mov_b64 exec, 15
    ds_read_b32 v119, v126 offset:23552
    v_mov_b32 v127, 0
    buffer_atomic_add v127, v126, s[12:15], s48 offen sc0 sc1
    s_waitcnt vmcnt(0) lgkmcnt(0)
    v_cmp_eq_u32 vcc, v119, v127
    s_mov_b64 exec, -1
    s_cbranch_vccnz sorted
    v_mov_b32 v126, 0
    ds_write_b32 v126, v125 offset:23588
    v_cmpx_lt_u32 vcc, 0, v58
    s_cbranch_execz pf_done
    buffer_load_dword v119, v0, s[4:7], 0 offen
    buffer_load_dword v119, v0, s[4:7], 0 offen offset:128
pf_done:
    s_mov_b64 exec, -1
    s_branch sorted
sorter:
    s_setprio 3
    v_lshlrev_b32 v80, 2, v113
    v_add_u32 v78, 20544, v80
    ds_read_b32 v72, v78
    ds_read_b32 v73, v78 offset:256
    v_cmp_gt_u32 s[20:21], 36, v113
    v_add_u32 v81, 64, v113
    v_mov_b32 v123, 21056
    v_mov_b32 v122, 16
    ds_write_b32 v118, v122 offset:12
    s_waitcnt lgkmcnt(1)
    v_add_u32 v74, 1, v72
    v_lshrrev_b32 v74, 1, v74
    v_min_u32 v74, 63, v74
    v_sub_u32 v74, 63, v74
    v_lshlrev_b32 v74, 2, v74
    v_add_u32 v75, 1, v73
    v_lshrrev_b32 v75, 1, v75
    v_min_u32 v75, 63, v75
    v_sub_u32 v75, 63, v75
    v_lshlrev_b32 v75, 2, v75
    v_add_u32 v84, v123, v74
    v_add_u32 v85, v123, v75
    ds_add_rtn_u32 v76, v84, v125
    s_mov_b64 exec, s[20:21]
    ds_add_rtn_u32 v77, v85, v125
    s_mov_b64 exec, -1
    ds_read_b32 v82, v78 offset:512
    s_waitcnt lgkmcnt(0)
    v_mov_b32 v83, v82
    s_nop 1
    v_add_u32_dpp v83, v83, v83 row_shr:1 row_mask:0xf bank_mask:0xf
    s_nop 1
    v_add_u32_dpp v83, v83, v83 row_shr:2 row_mask:0xf bank_mask:0xf
    s_nop 1
    v_add_u32_dpp v83, v83, v83 row_shr:4 row_mask:0xf bank_mask:0xf
    s_nop 1
    v_add_u32_dpp v83, v83, v83 row_shr:8 row_mask:0xf bank_mask:0xf
    s_nop 1
    v_add_u32_dpp v83, v83, v83 row_bcast:15 row_mask:0xa bank_mask:0xf
    s_nop 1
    v_add_u32_dpp v83, v83, v83 row_bcast:31 row_mask:0xc bank_mask:0xf
    v_sub_u32 v83, v83, v82
    ds_bpermute_b32 v74, v74, v83
    ds_bpermute_b32 v75, v75, v83
    v_mov_b32 v123, 22368
    s_waitcnt lgkmcnt(0)
    v_add_u32 v76, v76, v74
    v_add_u32 v77, v77, v75
    v_lshl_add_u32 v84, v76, 2, v123
    v_lshl_add_u32 v85, v77, 2, v123
    ds_write_b32 v84, v113
    ds_write_b32 v84, v72 offset:512
    s_mov_b64 exec, s[20:21]
    ds_write_b32 v85, v81
    ds_write_b32 v85, v73 offset:512
    s_mov_b64 exec, -1
    v_lshlrev_b32 v82, 4, v113
    v_add_u32 v82, 22880, v82
    ds_read_b128 v[84:87], v82
    v_cmp_gt_u32 vcc, 25, v113
    s_waitcnt lgkmcnt(0)
    v_max3_u32 v82, v84, v85, v86
    v_max_u32 v82, v82, v87
    v_add_u32 v82, 1, v82
    v_lshrrev_b32 v82, 1, v82
    v_max_u32 v82, 1, v82
    v_cndmask_b32 v82, 0, v82, vcc
    v_mov_b32 v83, v82
    s_nop 1
    v_add_u32_dpp v83, v83, v83 row_shr:1 row_mask:0xf bank_mask:0xf
    s_nop 1
    v_add_u32_dpp v83, v83, v83 row_shr:2 row_mask:0xf bank_mask:0xf
    s_nop 1
    v_add_u32_dpp v83, v83, v83 row_shr:4 row_mask:0xf bank_mask:0xf
    s_nop 1
    v_add_u32_dpp v83, v83, v83 row_shr:8 row_mask:0xf bank_mask:0xf
    s_nop 1
    v_add_u32_dpp v83, v83, v83 row_bcast:15 row_mask:0xa bank_mask:0xf
    s_nop 1
    v_add_u32_dpp v83, v83, v83 row_bcast:31 row_mask:0xc bank_mask:0xf
    s_nop 0
    v_readlane_b32 s48, v83, 63
    v_sub_u32 v83, v83, v82
    v_lshlrev_b32 v83, 6, v83
    v_and_b32 v74, -4, v76
    v_and_b32 v75, -4, v77
    ds_bpermute_b32 v74, v74, v83
    ds_bpermute_b32 v75, v75, v83
    v_lshl_or_b32 v82, v82, 16, v83
    v_cmpx_gt_u32 vcc, 32, v113
    ds_write_b32 v78, v82 offset:2848
    s_mov_b64 exec, -1
    s_cmp_gt_u32 s48, 284
    s_cbranch_scc0 fits
    ds_write_b32 v118, v125 offset:8
    s_branch sorted
fits:
    v_and_b32 v76, 3, v76
    v_and_b32 v77, 3, v77
    ds_add_u32 v78, v72 offset:800
    s_waitcnt lgkmcnt(1)
    v_lshl_add_u32 v74, v76, 3, v74
    v_lshl_add_u32 v75, v77, 3, v75
    ds_write_b32 v78, v74 offset:1312
    s_mov_b64 exec, s[20:21]
    ds_write_b32 v78, v75 offset:1568
    ds_add_u32 v78, v73 offset:1056
    s_mov_b64 exec, -1
sorted:
    s_waitcnt lgkmcnt(0)
    s_add_u32 s3, s3, 8
    s_mov_b64 exec, 1
    v_mov_b32 v126, 23520
    v_mov_b32 v127, 1
    ds_add_u32 v126, v127
    s_mov_b32 s70, 0x4000000
sw_c7:
    ds_read_b32 v127, v126
    s_sub_u32 s70, s70, 1
    s_cbranch_scc1 sw_out_c7
    s_waitcnt lgkmcnt(0)
    v_cmp_gt_u32 vcc, s3, v127
    s_cbranch_vccz sw_out_c7
    s_sleep 1
    s_branch sw_c7
sw_out_c7:
    s_waitcnt lgkmcnt(0)
    s_mov_b64 exec, -1
    ds_read_b32 v123, v118 offset:8
    v_cmpx_lt_u32 vcc, 0, v58
    ds_read_b32 v24, v24 offset:21856
    ds_read_b32 v25, v25 offset:21856
    s_mov_b64 exec, -1
    v_cmpx_lt_u32 vcc, 0, v59
    ds_read_b32 v26, v26 offset:21856
    ds_read_b32 v27, v27 offset:21856
    s_mov_b64 exec, -1
    v_cmpx_lt_u32 vcc, 8, v58
    ds_read_b32 v28, v28 offset:21856
    ds_read_b32 v29, v29 offset:21856
    s_mov_b64 exec, -1
    v_cmpx_lt_u32 vcc, 8, v59
    ds_read_b32 v30, v30 offset:21856
    ds_read_b32 v31, v31 offset:21856
    s_mov_b64 exec, -1
    s_nop 0
    s_waitcnt lgkmcnt(0)
    v_readfirstlane_b32 s48, v123
    s_cmp_eq_u32 s48, 0
    s_cbranch_scc1 place
    s_setprio 0
    s_mov_b32 s27, 512
    s_waitcnt lgkmcnt(0)
    s_add_u32 s3, s3, 8
    s_mov_b64 exec, 1
    v_mov_b32 v126, 23520
    v_mov_b32 v127, 1
    ds_add_u32 v126, v127
    s_mov_b32 s70, 0x4000000
sw_c8:
    ds_read_b32 v127, v126
    s_sub_u32 s70, s70, 1
    s_cbranch_scc1 sw_out_c8
    s_waitcnt lgkmcnt(0)
    v_cmp_gt_u32 vcc, s3, v127
    s_cbranch_vccz sw_out_c8
    s_sleep 1
    s_branch sw_c8
sw_out_c8:
    s_waitcnt lgkmcnt(0)
    s_mov_b64 exec, -1
    s_branch chain_init
place:
    v_cmpx_lt_u32 vcc, 0, v58
    v_bitop3_b32 v120, v24, 24, v24 bitop3:0x0c
    v_lshl_add_u32 v24, v36, 5, v24
    v_lshl_add_u32 v0, v120, 5, v0
    ds_write_b64 v24, v[0:1] offset:128
    v_cmpx_lt_u32 vcc, 1, v58
    v_bitop3_b32 v120, v25, 24, v25 bitop3:0x0c
    v_lshl_add_u32 v25, v37, 5, v25
    v_lshl_add_u32 v2, v120, 5, v2
    ds_write_b64 v25, v[2:3] offset:128
    s_mov_b64 exec, -1
    v_cmpx_lt_u32 vcc, 0, v59
    v_bitop3_b32 v120, v26, 24, v26 bitop3:0x0c
    v_lshl_add_u32 v26, v38, 5, v26
    v_lshl_add_u32 v12, v120, 5, v12
    ds_write_b64 v26, v[12:13] offset:128
    v_cmpx_lt_u32 vcc, 1, v59
    v_bitop3_b32 v120, v27, 24, v27 bitop3:0x0c
    v_lshl_add_u32 v27, v39, 5, v27
    v_lshl_add_u32 v14, v120, 5, v14
    ds_write_b64 v27, v[14:15] offset:128
    s_mov_b64 exec, -1
    v_cmpx_lt_u32 vcc, 8, v58
    v_bitop3_b32 v120, v28, 24, v28 bitop3:0x0c
    v_lshl_add_u32 v28, v40, 5, v28
    v_lshl_add_u32 v4, v120, 5, v4
    ds_write_b64 v28, v[4:5] offset:128
    v_cmpx_lt_u32 vcc, 9, v58
    v_bitop3_b32 v120, v29, 24, v29 bitop3:0x0c
    v_lshl_add_u32 v29, v41, 5, v29
    v_lshl_add_u32 v6, v120, 5, v6
    ds_write_b64 v29, v[6:7] offset:128
    s_mov_b64 exec, -1
    v_cmpx_lt_u32 vcc, 8, v59
    v_bitop3_b32 v120, v30, 24, v30 bitop3:0x0c
    v_lshl_add_u32 v30, v42, 5, v30
    v_lshl_add_u32 v16, v120, 5, v16
    ds_write_b64 v30, v[16:17] offset:128
    v_cmpx_lt_u32 vcc, 9, v59
    v_bitop3_b32 v120, v31, 24, v31 bitop3:0x0c
    v_lshl_add_u32 v31, v43, 5, v31
    v_lshl_add_u32 v18, v120, 5, v18
    ds_write_b64 v31, v[18:19] offset:128
    s_cmp_eq_u64 s[68:69], 0
    s_cbranch_scc1 placed
    s_mov_b64 exec, -1
    ds_read_b32 v32, v32 offset:21856
    ds_read_b32 v33, v33 offset:21856
    ds_read_b32 v34, v34 offset:21856
    ds_read_b32 v35, v35 offset:21856
    s_waitcnt lgkmcnt(0)
    s_mov_b64 exec, -1
    v_cmpx_lt_u32 vcc, 16, v58
    v_bitop3_b32 v120, v32, 24, v32 bitop3:0x0c
    v_lshl_add_u32 v32, v44, 5, v32
    v_lshl_add_u32 v8, v120, 5, v8
    ds_write_b64 v32, v[8:9] offset:128
    v_cmpx_lt_u32 vcc, 17, v58
    v_bitop3_b32 v120, v33, 24, v33 bitop3:0x0c
    v_lshl_add_u32 v33, v45, 5, v33
    v_lshl_add_u32 v10, v120, 5, v10
    ds_write_b64 v33, v[10:11] offset:128
    s_mov_b64 exec, -1
    v_cmpx_lt_u32 vcc, 16, v59
    v_bitop3_b32 v120, v34, 24, v34 bitop3:0x0c
    v_lshl_add_u32 v34, v46, 5, v34
    v_lshl_add_u32 v20, v120, 5, v20
    ds_write_b64 v34, v[20:21] offset:128
    v_cmpx_lt_u32 vcc, 17, v59
    v_bitop3_b32 v120, v35, 24, v35 bitop3:0x0c
    v_lshl_add_u32 v35, v47, 5, v35
    v_lshl_add_u32 v22, v120, 5, v22
    ds_write_b64 v35, v[22:23] offset:128
placed:
    s_mov_b64 exec, -1
    v_add_u32 v110, v110, v56
    v_sub_u32 v111, v111, v56
    v_add_u32 v114, v114, v57
    v_sub_u32 v117, v117, v57
    s_branch joined
cb_tables:
    s_mov_b32 s20, s54
    s_and_b32 s21, s55, 0xffff
    s_mov_b32 s22, 0x200
    s_mov_b32 s23, 0x20000
    s_mov_b32 s8, s52
    s_and_b32 s9, s53, 0xffff
    s_mov_b32 s10, 0x20200
    s_mov_b32 s11, 0x20000
    v_lshrrev_b32 v0, 5, v113
    v_bfe_u32 v1, v113, 1, 4
    v_and_b32 v2, 1, v113
    v_lshl_add_u32 v3, v0, 7, v1
    v_lshl_add_u32 v3, v2, 4, v3
    v_lshlrev_b32 v3, 1, v3
    s_mov_b32 s48, 131072
    buffer_load_ushort v4, v3, s[20:23], 0 offen offset:0
    buffer_load_ushort v8, v3, s[8:11], s48 offen offset:0
    buffer_load_ushort v5, v3, s[20:23], 0 offen offset:64
    buffer_load_ushort v9, v3, s[8:11], s48 offen offset:64
    buffer_load_ushort v6, v3, s[20:23], 0 offen offset:128
    buffer_load_ushort v10, v3, s[8:11], s48 offen offset:128
    buffer_load_ushort v7, v3, s[20:23], 0 offen offset:192
    buffer_load_ushort v11, v3, s[8:11], s48 offen offset:192
    v_cmp_eq_u32 vcc, 1, v2
    v_mov_b32 v12, 0x3fb8aa3b
    v_mov_b32 v13, 0x25b8aa3b
    v_cndmask_b32 v12, v12, v13, vcc
    v_lshlrev_b32 v14, 4, v113
    s_waitcnt vmcnt(0)
    v_lshlrev_b32 v4, 16, v4
    v_mul_f32 v4, v4, v12
    v_lshlrev_b32 v5, 16, v5
    v_mul_f32 v5, v5, v12
    v_lshlrev_b32 v6, 16, v6
    v_mul_f32 v6, v6, v12
    v_lshlrev_b32 v7, 16, v7
    v_mul_f32 v7, v7, v12
    v_lshlrev_b32 v8, 16, v8
    v_mul_f32 v8, v8, v12
    v_lshlrev_b32 v9, 16, v9
    v_mul_f32 v9, v9, v12
    v_lshlrev_b32 v10, 16, v10
    v_mul_f32 v10, v10, v12
    v_lshlrev_b32 v11, 16, v11
    v_mul_f32 v11, v11, v12
    ds_write_b128 v14, v[8:11] offset:18496
    ds_write_b128 v14, v[4:7] offset:19520
    s_branch chain_init
frag_w2:
    s_cmp_ge_u32 s2, 64
    s_cbranch_scc1 chain_init
    s_mov_b32 s20, s66
    s_and_b32 s21, s67, 0xffff
    s_mov_b32 s22, 0x10000
    s_mov_b32 s23, 0x20000
    v_and_b32 v16, 31, v113
    v_lshrrev_b32 v0, 5, v113
    s_and_b32 s48, s2, 7
    s_lshl_b32 s48, s48, 1
    s_bfe_u32 s49, s2, 0x10003
    s_lshl_b32 s49, s49, 7
    s_add_u32 s48, s48, s49
    v_add_u32 v17, s48, v0
    v_lshlrev_b32 v17, 8, v17
    s_lshr_b32 s48, s2, 4
    s_lshl_b32 s48, s48, 6
    v_add_u32 v17, s48, v17
    v_bfe_u32 v18, v16, 2, 1
    v_lshl_add_u32 v17, v18, 5, v17
    v_lshrrev_b32 v18, 3, v16
    v_lshl_add_u32 v17, v18, 3, v17
    v_and_b32 v18, 3, v16
    v_lshl_add_u32 v17, v18, 1, v17
    s_mov_b32 s48, 0
    buffer_load_ushort v20, v17, s[20:23], s48 offen
    s_mov_b32 s48, 8192
    buffer_load_ushort v21, v17, s[20:23], s48 offen
    s_mov_b32 s48, 16384
    buffer_load_ushort v22, v17, s[20:23], s48 offen
    s_mov_b32 s48, 24576
    buffer_load_ushort v23, v17, s[20:23], s48 offen
    s_mov_b32 s48, 4096
    buffer_load_ushort v24, v17, s[20:23], s48 offen
    s_mov_b32 s48, 12288
    buffer_load_ushort v25, v17, s[20:23], s48 offen
    s_mov_b32 s48, 20480
    buffer_load_ushort v26, v17, s[20:23], s48 offen
    s_mov_b32 s48, 28672
    buffer_load_ushort v27, v17, s[20:23], s48 offen
    s_lshl_b32 s48, s2, 10
    s_add_u32 s48, s48, 0x3a0000
    v_lshlrev_b32 v14, 4, v113
    s_waitcnt vmcnt(0)
    v_lshl_or_b32 v16, v21, 16, v20
    v_lshl_or_b32 v17, v23, 16, v22
    v_lshl_or_b32 v18, v25, 16, v24
    v_lshl_or_b32 v19, v27, 16, v26
    buffer_store_dwordx4 v[16:19], v14, s[12:15], s48 offen sc1
    s_branch chain_init
helper:
    s_sub_u32 s28, s25, 8
    v_lshrrev_b32 v120, 5, v113
    v_lshlrev_b32 v121, 1, v120
    v_and_b32 v117, 31, v113
    v_xor_b32 v117, v117, v121
    v_lshlrev_b32 v117, 4, v117
    v_lshl_add_u32 v117, v120, 9, v117
    s_and_b32 s30, s28, 3
    s_lshl_b32 s30, s30, 12
    s_lshr_b32 s48, s28, 2
    s_lshl_b32 s48, s48, 11
    s_add_u32 s30, s30, s48
    s_mul_i32 s31, s28, 2176
    s_lshr_b32 s29, s2, 2
    s_and_b32 s29, s29, 2
    s_mul_i32 s51, s24, 98
    s_and_b32 s48, s28, 3
    s_lshl_b32 s48, s48, 5
    s_add_u32 s51, s51, s48
    v_and_b32 v120, 15, v113
    v_lshrrev_b32 v121, 4, v113
    v_xor_b32 v118, v120, v121
    v_lshlrev_b32 v118, 4, v118
    v_lshl_add_u32 v118, v121, 8, v118
    s_waitcnt lgkmcnt(0)
    s_mov_b32 s8, s40
    s_and_b32 s9, s41, 0xffff
    s_mov_b32 s10, 0x61a800
    s_mov_b32 s11, 0x20000
    s_mov_b32 s32, s52
    s_and_b32 s33, s53, 0xffff
    s_mov_b32 s34, 0x20200
    s_mov_b32 s35, 0x20000
    s_add_u32 s10, s24, 1
    s_mul_i32 s10, s10, 25088
    s_min_u32 s10, s10, 0x61a800
    s_mul_i32 s50, s24, 25088
    s_add_u32 s49, s28, 0
    s_mul_i32 s48, s49, 1088
    s_add_u32 m0, s48, 23616
    s_lshl_b32 s49, s49, 10
    s_add_u32 s49, s49, s50
    buffer_load_dwordx4 v118, s[8:11], s49 offen lds
    s_add_u32 s49, s28, 8
    s_mul_i32 s48, s49, 1088
    s_add_u32 m0, s48, 23616
    s_lshl_b32 s49, s49, 10
    s_add_u32 s49, s49, s50
    buffer_load_dwordx4 v118, s[8:11], s49 offen lds
    s_add_u32 s49, s28, 16
    s_mul_i32 s48, s49, 1088
    s_add_u32 m0, s48, 23616
    s_lshl_b32 s49, s49, 10
    s_add_u32 s49, s49, s50
    buffer_load_dwordx4 v118, s[8:11], s49 offen lds
    s_cmp_lg_u32 s25, 8
    s_cbranch_scc1 x_issued
    s_add_u32 s49, s28, 24
    s_mul_i32 s48, s49, 1088
    s_add_u32 m0, s48, 23616
    s_lshl_b32 s49, s49, 10
    s_add_u32 s49, s49, s50
    buffer_load_dwordx4 v118, s[8:11], s49 offen lds
x_issued:
    s_add_u32 s48, s29, 0
    s_and_b32 s48, s48, 3
    s_lshl_b32 s49, s48, 14
    s_add_u32 s49, s49, s30
    s_add_u32 m0, s31, 93248
    s_nop 0
    buffer_load_dwordx4 v117, s[32:35], s49 offen lds
    s_add_u32 m0, s31, 94336
    s_add_u32 s49, s49, 1024
    buffer_load_dwordx4 v117, s[32:35], s49 offen lds
    s_add_u32 s48, s29, 1
    s_and_b32 s48, s48, 3
    s_lshl_b32 s49, s48, 14
    s_add_u32 s49, s49, s30
    s_add_u32 m0, s31, 110656
    s_nop 0
    buffer_load_dwordx4 v117, s[32:35], s49 offen lds
    s_add_u32 m0, s31, 111744
    s_add_u32 s49, s49, 1024
    buffer_load_dwordx4 v117, s[32:35], s49 offen lds
    s_mov_b32 s12, s62
    s_and_b32 s13, s63, 0xffff
    s_mov_b32 s14, 0x5000000
    s_mov_b32 s15, 0x20000
    s_mov_b32 s72, s60
    s_and_b32 s73, s61, 0xffff
    s_mov_b32 s74, 0x100
    s_mov_b32 s75, 0x20000
    s_add_u32 s4, s62, 0x400000
    s_addc_u32 s5, s63, 0
    s_and_b32 s5, s5, 0xffff
    s_mov_b32 s6, 0xc35200
    s_mov_b32 s7, 0x20000
    s_mov_b32 s16, s58
    s_and_b32 s17, s59, 0xffff
    s_mov_b32 s18, 0x61a800
    s_mov_b32 s19, 0x20000
    s_add_u32 s76, s62, 0x3ffd00
    s_addc_u32 s77, s63, 0
    s_and_b32 s77, s77, 0xffff
    s_or_b32 s77, s77, 0x100000
    s_mov_b32 s78, 64
    s_mov_b32 s79, 0x800000
    s_getpc_b64 s[20:21]
pc_here:
    s_add_u32 s20, s20, lut_jobs - pc_here
    s_addc_u32 s21, s21, 0
    s_lshl_b32 s49, s25, 3
    s_load_dwordx2 s[64:65], s[20:21], s49
    v_lshl_add_u32 v116, v121, 2, s51
    v_lshlrev_b32 v116, 9, v116
    v_lshl_add_u32 v116, v120, 4, v116
    s_lshr_b32 s48, s28, 2
    s_lshl_b32 s48, s48, 8
    v_add_u32 v116, s48, v116
    v_and_b32 v120, 15, v113
    v_lshrrev_b32 v121, 4, v113
    v_lshrrev_b32 v96, 3, v120
    v_lshl_add_u32 v96, v121, 1, v96
    v_mul_u32_u24 v114, 1088, v96
    s_lshr_b32 s48, s28, 2
    s_lshl_b32 s48, s48, 8
    s_add_u32 s48, s48, 93248
    v_add_u32 v114, s48, v114
    v_and_b32 v96, 3, v120
    v_lshl_add_u32 v114, v96, 3, v114
    v_bfe_u32 v96, v120, 2, 1
    v_mul_u32_u24 v97, 480, v96
    v_add_u32 v115, v97, v114
    v_mul_u32_u24 v97, 544, v96
    v_add_u32 v114, v97, v114
    v_and_b32 v120, 15, v113
    v_lshrrev_b32 v121, 4, v113
    v_lshrrev_b32 v96, 2, v120
    v_mul_u32_u24 v96, 1088, v96
    v_and_b32 v97, 3, v120
    v_lshl_add_u32 v96, v97, 8, v96
    v_xor_b32 v97, v97, v121
    v_lshl_add_u32 v96, v97, 4, v96
    s_and_b32 s48, s28, 3
    s_mul_i32 s48, s48, 8704
    s_add_u32 s48, s48, 23616
    s_lshl_b32 s49, s29, 6
    s_add_u32 s49, s49, s48
    v_add_u32 v97, s49, v96
    s_xor_b32 s49, s29, 2
    s_lshl_b32 s49, s49, 6
    s_add_u32 s49, s49, s48
    v_add_u32 v98, s49, v96
    s_waitcnt vmcnt(0) lgkmcnt(0)
    s_add_u32 s3, s3, 8
    s_mov_b64 exec, 1
    v_mov_b32 v126, 23524
    v_mov_b32 v127, 1
    ds_add_u32 v126, v127
    s_mov_b64 exec, -1
    s_add_u32 s48, s29, 2
    s_and_b32 s48, s48, 3
    s_lshl_b32 s49, s48, 14
    s_add_u32 s49, s49, s30
    s_add_u32 m0, s31, 128064
    s_nop 0
    buffer_load_dwordx4 v117, s[32:35], s49 offen lds
    s_add_u32 m0, s31, 129152
    s_add_u32 s49, s49, 1024
    buffer_load_dwordx4 v117, s[32:35], s49 offen lds
    s_add_u32 s48, s29, 3
    s_and_b32 s48, s48, 3
    s_lshl_b32 s49, s48, 14
    s_add_u32 s49, s49, s30
    s_add_u32 m0, s31, 145472
    s_nop 0
    buffer_load_dwordx4 v117, s[32:35], s49 offen lds
    s_add_u32 m0, s31, 146560
    s_add_u32 s49, s49, 1024
    buffer_load_dwordx4 v117, s[32:35], s49 offen lds
    s_mov_b64 exec, 1
    s_mov_b32 s70, 0x4000000
sw_h0:
    ds_read_b32 v127, v126
    s_sub_u32 s70, s70, 1
    s_cbranch_scc1 sw_out_h0
    s_waitcnt lgkmcnt(0)
    v_cmp_gt_u32 vcc, s3, v127
    s_cbranch_vccz sw_out_h0
    s_sleep 1
    s_branch sw_h0
sw_out_h0:
    s_waitcnt lgkmcnt(0)
    s_mov_b64 exec, -1
    ds_read_b128 v[64:67], v97 offset:0
    ds_read_b128 v[80:83], v97 offset:4352
    ds_read_b128 v[68:71], v97 offset:64
    ds_read_b128 v[84:87], v97 offset:4416
    ds_read_b128 v[72:75], v98 offset:0
    ds_read_b128 v[88:91], v98 offset:4352
    ds_read_b128 v[76:79], v98 offset:64
    ds_read_b128 v[92:95], v98 offset:4416
    s_waitcnt lgkmcnt(0)
    ds_read_b64_tr_b16 v[96:97], v114 offset:0
    ds_read_b64_tr_b16 v[98:99], v114 offset:8704
    ds_read_b64_tr_b16 v[100:101], v115 offset:32
    ds_read_b64_tr_b16 v[102:103], v115 offset:8736
    ds_read_b64_tr_b16 v[104:105], v114 offset:64
    ds_read_b64_tr_b16 v[106:107], v114 offset:8768
    ds_read_b64_tr_b16 v[108:109], v115 offset:96
    ds_read_b64_tr_b16 v[110:111], v115 offset:8800
    s_waitcnt lgkmcnt(6)
    v_mfma_f32_16x16x32_bf16 v[0:3], v[64:67], v[96:99], 0
    v_mfma_f32_16x16x32_bf16 v[32:35], v[80:83], v[96:99], 0
    ds_read_b64_tr_b16 v[96:97], v114 offset:128
    ds_read_b64_tr_b16 v[98:99], v114 offset:8832
    s_waitcnt lgkmcnt(6)
    v_mfma_f32_16x16x32_bf16 v[4:7], v[64:67], v[100:103], 0
    v_mfma_f32_16x16x32_bf16 v[36:39], v[80:83], v[100:103], 0
    ds_read_b64_tr_b16 v[100:101], v115 offset:160
    ds_read_b64_tr_b16 v[102:103], v115 offset:8864
    s_waitcnt lgkmcnt(6)
    v_mfma_f32_16x16x32_bf16 v[8:11], v[64:67], v[104:107], 0
    v_mfma_f32_16x16x32_bf16 v[40:43], v[80:83], v[104:107], 0
    ds_read_b64_tr_b16 v[104:105], v114 offset:192
    ds_read_b64_tr_b16 v[106:107], v114 offset:8896
    s_waitcnt lgkmcnt(6)
    v_mfma_f32_16x16x32_bf16 v[12:15], v[64:67], v[108:111], 0
    v_mfma_f32_16x16x32_bf16 v[44:47], v[80:83], v[108:111], 0
    ds_read_b64_tr_b16 v[108:109], v115 offset:224
    ds_read_b64_tr_b16 v[110:111], v115 offset:8928
    s_waitcnt lgkmcnt(6)
    v_mfma_f32_16x16x32_bf16 v[16:19], v[64:67], v[96:99], 0
    v_mfma_f32_16x16x32_bf16 v[48:51], v[80:83], v[96:99], 0
    ds_read_b64_tr_b16 v[96:97], v114 offset:17408
    ds_read_b64_tr_b16 v[98:99], v114 offset:26112
    s_waitcnt lgkmcnt(6)
    v_mfma_f32_16x16x32_bf16 v[20:23], v[64:67], v[100:103], 0
    v_mfma_f32_16x16x32_bf16 v[52:55], v[80:83], v[100:103], 0
    ds_read_b64_tr_b16 v[100:101], v115 offset:17440
    ds_read_b64_tr_b16 v[102:103], v115 offset:26144
    s_waitcnt lgkmcnt(6)
    v_mfma_f32_16x16x32_bf16 v[24:27], v[64:67], v[104:107], 0
    v_mfma_f32_16x16x32_bf16 v[56:59], v[80:83], v[104:107], 0
    ds_read_b64_tr_b16 v[104:105], v114 offset:17472
    ds_read_b64_tr_b16 v[106:107], v114 offset:26176
    s_waitcnt lgkmcnt(6)
    v_mfma_f32_16x16x32_bf16 v[28:31], v[64:67], v[108:111], 0
    v_mfma_f32_16x16x32_bf16 v[60:63], v[80:83], v[108:111], 0
    ds_read_b64_tr_b16 v[108:109], v115 offset:17504
    ds_read_b64_tr_b16 v[110:111], v115 offset:26208
    s_waitcnt lgkmcnt(6)
    v_mfma_f32_16x16x32_bf16 v[0:3], v[68:71], v[96:99], v[0:3]
    v_mfma_f32_16x16x32_bf16 v[32:35], v[84:87], v[96:99], v[32:35]
    ds_read_b64_tr_b16 v[96:97], v114 offset:17536
    ds_read_b64_tr_b16 v[98:99], v114 offset:26240
    s_waitcnt lgkmcnt(6)
    v_mfma_f32_16x16x32_bf16 v[4:7], v[68:71], v[100:103], v[4:7]
    v_mfma_f32_16x16x32_bf16 v[36:39], v[84:87], v[100:103], v[36:39]
    ds_read_b64_tr_b16 v[100:101], v115 offset:17568
    ds_read_b64_tr_b16 v[102:103], v115 offset:26272
    s_waitcnt lgkmcnt(6)
    v_mfma_f32_16x16x32_bf16 v[8:11], v[68:71], v[104:107], v[8:11]
    v_mfma_f32_16x16x32_bf16 v[40:43], v[84:87], v[104:107], v[40:43]
    ds_read_b64_tr_b16 v[104:105], v114 offset:17600
    ds_read_b64_tr_b16 v[106:107], v114 offset:26304
    s_waitcnt lgkmcnt(6)
    v_mfma_f32_16x16x32_bf16 v[12:15], v[68:71], v[108:111], v[12:15]
    v_mfma_f32_16x16x32_bf16 v[44:47], v[84:87], v[108:111], v[44:47]
    ds_read_b64_tr_b16 v[108:109], v115 offset:17632
    ds_read_b64_tr_b16 v[110:111], v115 offset:26336
    s_waitcnt lgkmcnt(6)
    v_mfma_f32_16x16x32_bf16 v[16:19], v[68:71], v[96:99], v[16:19]
    v_mfma_f32_16x16x32_bf16 v[48:51], v[84:87], v[96:99], v[48:51]
    s_waitcnt lgkmcnt(4)
    v_mfma_f32_16x16x32_bf16 v[20:23], v[68:71], v[100:103], v[20:23]
    v_mfma_f32_16x16x32_bf16 v[52:55], v[84:87], v[100:103], v[52:55]
    s_waitcnt lgkmcnt(2)
    v_mfma_f32_16x16x32_bf16 v[24:27], v[68:71], v[104:107], v[24:27]
    v_mfma_f32_16x16x32_bf16 v[56:59], v[84:87], v[104:107], v[56:59]
    s_waitcnt lgkmcnt(0)
    v_mfma_f32_16x16x32_bf16 v[28:31], v[68:71], v[108:111], v[28:31]
    v_mfma_f32_16x16x32_bf16 v[60:63], v[84:87], v[108:111], v[60:63]
    s_waitcnt vmcnt(0) lgkmcnt(0)
    s_add_u32 s3, s3, 8
    s_mov_b64 exec, 1
    v_mov_b32 v126, 23524
    v_mov_b32 v127, 1
    ds_add_u32 v126, v127
    s_mov_b32 s70, 0x4000000
sw_h1:
    ds_read_b32 v127, v126
    s_sub_u32 s70, s70, 1
    s_cbranch_scc1 sw_out_h1
    s_waitcnt lgkmcnt(0)
    v_cmp_gt_u32 vcc, s3, v127
    s_cbranch_vccz sw_out_h1
    s_sleep 1
    s_branch sw_h1
sw_out_h1:
    s_waitcnt lgkmcnt(0)
    s_mov_b64 exec, -1
    s_bitcmp0_b32 s28, 2
    s_cbranch_scc1 no_wb
    s_add_u32 s48, s29, 0
    s_and_b32 s48, s48, 3
    s_lshl_b32 s49, s48, 14
    s_add_u32 s49, s49, s30
    s_add_u32 s49, s49, 65536
    s_add_u32 m0, s31, 23616
    s_nop 0
    buffer_load_dwordx4 v117, s[32:35], s49 offen lds
    s_add_u32 m0, s31, 24704
    s_add_u32 s49, s49, 1024
    buffer_load_dwordx4 v117, s[32:35], s49 offen lds
    s_add_u32 s48, s29, 1
    s_and_b32 s48, s48, 3
    s_lshl_b32 s49, s48, 14
    s_add_u32 s49, s49, s30
    s_add_u32 s49, s49, 65536
    s_add_u32 m0, s31, 41024
    s_nop 0
    buffer_load_dwordx4 v117, s[32:35], s49 offen lds
    s_add_u32 m0, s31, 42112
    s_add_u32 s49, s49, 1024
    buffer_load_dwordx4 v117, s[32:35], s49 offen lds
    s_add_u32 s48, s29, 2
    s_and_b32 s48, s48, 3
    s_lshl_b32 s49, s48, 14
    s_add_u32 s49, s49, s30
    s_add_u32 s49, s49, 65536
    s_add_u32 m0, s31, 58432
    s_nop 0
    buffer_load_dwordx4 v117, s[32:35], s49 offen lds
    s_add_u32 m0, s31, 59520
    s_add_u32 s49, s49, 1024
    buffer_load_dwordx4 v117, s[32:35], s49 offen lds
    s_add_u32 s48, s29, 3
    s_and_b32 s48, s48, 3
    s_lshl_b32 s49, s48, 14
    s_add_u32 s49, s49, s30
    s_add_u32 s49, s49, 65536
    s_add_u32 m0, s31, 75840
    s_nop 0
    buffer_load_dwordx4 v117, s[32:35], s49 offen lds
    s_add_u32 m0, s31, 76928
    s_add_u32 s49, s49, 1024
    buffer_load_dwordx4 v117, s[32:35], s49 offen lds
    s_sub_u32 s30, s30, 2048
    s_sub_u32 s31, s31, 8704
    s_add_u32 s48, s29, 0
    s_and_b32 s48, s48, 3
    s_lshl_b32 s49, s48, 14
    s_add_u32 s49, s49, s30
    s_add_u32 s49, s49, 65536
    s_add_u32 m0, s31, 23616
    s_nop 0
    buffer_load_dwordx4 v117, s[32:35], s49 offen lds
    s_add_u32 m0, s31, 24704
    s_add_u32 s49, s49, 1024
    buffer_load_dwordx4 v117, s[32:35], s49 offen lds
    s_add_u32 s48, s29, 1
    s_and_b32 s48, s48, 3
    s_lshl_b32 s49, s48, 14
    s_add_u32 s49, s49, s30
    s_add_u32 s49, s49, 65536
    s_add_u32 m0, s31, 41024
    s_nop 0
    buffer_load_dwordx4 v117, s[32:35], s49 offen lds
    s_add_u32 m0, s31, 42112
    s_add_u32 s49, s49, 1024
    buffer_load_dwordx4 v117, s[32:35], s49 offen lds
    s_add_u32 s48, s29, 2
    s_and_b32 s48, s48, 3
    s_lshl_b32 s49, s48, 14
    s_add_u32 s49, s49, s30
    s_add_u32 s49, s49, 65536
    s_add_u32 m0, s31, 58432
    s_nop 0
    buffer_load_dwordx4 v117, s[32:35], s49 offen lds
    s_add_u32 m0, s31, 59520
    s_add_u32 s49, s49, 1024
    buffer_load_dwordx4 v117, s[32:35], s49 offen lds
    s_add_u32 s48, s29, 3
    s_and_b32 s48, s48, 3
    s_lshl_b32 s49, s48, 14
    s_add_u32 s49, s49, s30
    s_add_u32 s49, s49, 65536
    s_add_u32 m0, s31, 75840
    s_nop 0
    buffer_load_dwordx4 v117, s[32:35], s49 offen lds
    s_add_u32 m0, s31, 76928
    s_add_u32 s49, s49, 1024
    buffer_load_dwordx4 v117, s[32:35], s49 offen lds
no_wb:
    ds_read_b64_tr_b16 v[96:97], v114 offset:34816
    ds_read_b64_tr_b16 v[98:99], v114 offset:43520
    ds_read_b64_tr_b16 v[100:101], v115 offset:34848
    ds_read_b64_tr_b16 v[102:103], v115 offset:43552
    ds_read_b64_tr_b16 v[104:105], v114 offset:34880
    ds_read_b64_tr_b16 v[106:107], v114 offset:43584
    ds_read_b64_tr_b16 v[108:109], v115 offset:34912
    ds_read_b64_tr_b16 v[110:111], v115 offset:43616
    s_waitcnt lgkmcnt(6)
    v_mfma_f32_16x16x32_bf16 v[0:3], v[72:75], v[96:99], v[0:3]
    v_mfma_f32_16x16x32_bf16 v[32:35], v[88:91], v[96:99], v[32:35]
    ds_read_b64_tr_b16 v[96:97], v114 offset:34944
    ds_read_b64_tr_b16 v[98:99], v114 offset:43648
    s_waitcnt lgkmcnt(6)
    v_mfma_f32_16x16x32_bf16 v[4:7], v[72:75], v[100:103], v[4:7]
    v_mfma_f32_16x16x32_bf16 v[36:39], v[88:91], v[100:103], v[36:39]
    ds_read_b64_tr_b16 v[100:101], v115 offset:34976
    ds_read_b64_tr_b16 v[102:103], v115 offset:43680
    s_waitcnt lgkmcnt(6)
    v_mfma_f32_16x16x32_bf16 v[8:11], v[72:75], v[104:107], v[8:11]
    v_mfma_f32_16x16x32_bf16 v[40:43], v[88:91], v[104:107], v[40:43]
    ds_read_b64_tr_b16 v[104:105], v114 offset:35008
    ds_read_b64_tr_b16 v[106:107], v114 offset:43712
    s_waitcnt lgkmcnt(6)
    v_mfma_f32_16x16x32_bf16 v[12:15], v[72:75], v[108:111], v[12:15]
    v_mfma_f32_16x16x32_bf16 v[44:47], v[88:91], v[108:111], v[44:47]
    ds_read_b64_tr_b16 v[108:109], v115 offset:35040
    ds_read_b64_tr_b16 v[110:111], v115 offset:43744
    s_waitcnt lgkmcnt(6)
    v_mfma_f32_16x16x32_bf16 v[16:19], v[72:75], v[96:99], v[16:19]
    v_mfma_f32_16x16x32_bf16 v[48:51], v[88:91], v[96:99], v[48:51]
    ds_read_b64_tr_b16 v[96:97], v114 offset:52224
    ds_read_b64_tr_b16 v[98:99], v114 offset:60928
    s_waitcnt lgkmcnt(6)
    v_mfma_f32_16x16x32_bf16 v[20:23], v[72:75], v[100:103], v[20:23]
    v_mfma_f32_16x16x32_bf16 v[52:55], v[88:91], v[100:103], v[52:55]
    ds_read_b64_tr_b16 v[100:101], v115 offset:52256
    ds_read_b64_tr_b16 v[102:103], v115 offset:60960
    s_waitcnt lgkmcnt(6)
    v_mfma_f32_16x16x32_bf16 v[24:27], v[72:75], v[104:107], v[24:27]
    v_mfma_f32_16x16x32_bf16 v[56:59], v[88:91], v[104:107], v[56:59]
    ds_read_b64_tr_b16 v[104:105], v114 offset:52288
    ds_read_b64_tr_b16 v[106:107], v114 offset:60992
    s_waitcnt lgkmcnt(6)
    v_mfma_f32_16x16x32_bf16 v[28:31], v[72:75], v[108:111], v[28:31]
    v_mfma_f32_16x16x32_bf16 v[60:63], v[88:91], v[108:111], v[60:63]
    ds_read_b64_tr_b16 v[108:109], v115 offset:52320
    ds_read_b64_tr_b16 v[110:111], v115 offset:61024
    s_waitcnt lgkmcnt(6)
    v_mfma_f32_16x16x32_bf16 v[0:3], v[76:79], v[96:99], v[0:3]
    v_mfma_f32_16x16x32_bf16 v[32:35], v[92:95], v[96:99], v[32:35]
    ds_read_b64_tr_b16 v[96:97], v114 offset:52352
    ds_read_b64_tr_b16 v[98:99], v114 offset:61056
    s_waitcnt lgkmcnt(6)
    v_mfma_f32_16x16x32_bf16 v[4:7], v[76:79], v[100:103], v[4:7]
    v_mfma_f32_16x16x32_bf16 v[36:39], v[92:95], v[100:103], v[36:39]
    ds_read_b64_tr_b16 v[100:101], v115 offset:52384
    ds_read_b64_tr_b16 v[102:103], v115 offset:61088
    s_waitcnt lgkmcnt(6)
    v_mfma_f32_16x16x32_bf16 v[8:11], v[76:79], v[104:107], v[8:11]
    v_mfma_f32_16x16x32_bf16 v[40:43], v[92:95], v[104:107], v[40:43]
    ds_read_b64_tr_b16 v[104:105], v114 offset:52416
    ds_read_b64_tr_b16 v[106:107], v114 offset:61120
    s_waitcnt lgkmcnt(6)
    v_mfma_f32_16x16x32_bf16 v[12:15], v[76:79], v[108:111], v[12:15]
    v_mfma_f32_16x16x32_bf16 v[44:47], v[92:95], v[108:111], v[44:47]
    ds_read_b64_tr_b16 v[108:109], v115 offset:52448
    ds_read_b64_tr_b16 v[110:111], v115 offset:61152
    s_waitcnt lgkmcnt(6)
    v_mfma_f32_16x16x32_bf16 v[16:19], v[76:79], v[96:99], v[16:19]
    v_mfma_f32_16x16x32_bf16 v[48:51], v[92:95], v[96:99], v[48:51]
    s_waitcnt lgkmcnt(4)
    v_mfma_f32_16x16x32_bf16 v[20:23], v[76:79], v[100:103], v[20:23]
    v_mfma_f32_16x16x32_bf16 v[52:55], v[92:95], v[100:103], v[52:55]
    s_waitcnt lgkmcnt(2)
    v_mfma_f32_16x16x32_bf16 v[24:27], v[76:79], v[104:107], v[24:27]
    v_mfma_f32_16x16x32_bf16 v[56:59], v[92:95], v[104:107], v[56:59]
    s_waitcnt lgkmcnt(0)
    v_mfma_f32_16x16x32_bf16 v[28:31], v[76:79], v[108:111], v[28:31]
    v_mfma_f32_16x16x32_bf16 v[60:63], v[92:95], v[108:111], v[60:63]
    s_mov_b64 exec, 1
    v_mov_b32 v126, 23528
    v_mov_b32 v127, 1
    ds_add_u32 v126, v127
    s_mov_b64 exec, -1
    s_add_u32 s6, s24, 1
    s_mul_i32 s6, s6, 50176
    s_min_u32 s6, s6, 0xc35000
    s_mov_b32 s50, 0x07060100
    s_mov_b32 s51, 0x07060302
    s_mov_b32 s20, 8192
    s_mov_b32 s36, 0x3fb8aa3b
    s_mov_b32 s37, 0x3fb8aa3b
    s_mov_b32 s38, 0x25b8aa3b
    s_mov_b32 s39, 0x25b8aa3b
    s_bitcmp1_b32 s28, 2
    s_cbranch_scc1 second_half
    v_mul_f32 v0, s36, v0
    v_mul_f32 v1, s36, v1
    v_mul_f32 v2, s36, v2
    v_mul_f32 v3, s36, v3
    v_mul_f32 v4, s38, v4
    v_mul_f32 v5, s38, v5
    v_mul_f32 v6, s38, v6
    v_mul_f32 v7, s38, v7
    v_mul_f32 v8, s36, v8
    v_mul_f32 v9, s36, v9
    v_mul_f32 v10, s36, v10
    v_mul_f32 v11, s36, v11
    v_mul_f32 v12, s38, v12
    v_mul_f32 v13, s38, v13
    v_mul_f32 v14, s38, v14
    v_mul_f32 v15, s38, v15
    v_mul_f32 v16, s36, v16
    v_mul_f32 v17, s36, v17
    v_mul_f32 v18, s36, v18
    v_mul_f32 v19, s36, v19
    v_mul_f32 v20, s38, v20
    v_mul_f32 v21, s38, v21
    v_mul_f32 v22, s38, v22
    v_mul_f32 v23, s38, v23
    v_mul_f32 v24, s36, v24
    v_mul_f32 v25, s36, v25
    v_mul_f32 v26, s36, v26
    v_mul_f32 v27, s36, v27
    v_mul_f32 v28, s38, v28
    v_mul_f32 v29, s38, v29
    v_mul_f32 v30, s38, v30
    v_mul_f32 v31, s38, v31
    v_cvt_pk_bf16_f32 v120, v0, v8
    v_cvt_pk_bf16_f32 v121, v16, v24
    v_perm_b32 v96, v4, v120, s50
    v_perm_b32 v97, v12, v120, s51
    v_perm_b32 v98, v20, v121, s50
    v_perm_b32 v99, v28, v121, s51
    buffer_store_dwordx4 v[96:99], v116, s[4:7], 0 offen offset:0 sc1
    v_cvt_pk_bf16_f32 v120, v1, v9
    v_cvt_pk_bf16_f32 v121, v17, v25
    v_perm_b32 v100, v5, v120, s50
    v_perm_b32 v101, v13, v120, s51
    v_perm_b32 v102, v21, v121, s50
    v_perm_b32 v103, v29, v121, s51
    buffer_store_dwordx4 v[100:103], v116, s[4:7], 0 offen offset:512 sc1
    v_cvt_pk_bf16_f32 v120, v2, v10
    v_cvt_pk_bf16_f32 v121, v18, v26
    v_perm_b32 v104, v6, v120, s50
    v_perm_b32 v105, v14, v120, s51
    v_perm_b32 v106, v22, v121, s50
    v_perm_b32 v107, v30, v121, s51
    buffer_store_dwordx4 v[104:107], v116, s[4:7], 0 offen offset:1024 sc1
    v_cvt_pk_bf16_f32 v120, v3, v11
    v_cvt_pk_bf16_f32 v121, v19, v27
    v_perm_b32 v108, v7, v120, s50
    v_perm_b32 v109, v15, v120, s51
    v_perm_b32 v110, v23, v121, s50
    v_perm_b32 v111, v31, v121, s51
    buffer_store_dwordx4 v[108:111], v116, s[4:7], 0 offen offset:1536 sc1
    v_mul_f32 v32, s36, v32
    v_mul_f32 v33, s36, v33
    v_mul_f32 v34, s36, v34
    v_mul_f32 v35, s36, v35
    v_mul_f32 v36, s38, v36
    v_mul_f32 v37, s38, v37
    v_mul_f32 v38, s38, v38
    v_mul_f32 v39, s38, v39
    v_mul_f32 v40, s36, v40
    v_mul_f32 v41, s36, v41
    v_mul_f32 v42, s36, v42
    v_mul_f32 v43, s36, v43
    v_mul_f32 v44, s38, v44
    v_mul_f32 v45, s38, v45
    v_mul_f32 v46, s38, v46
    v_mul_f32 v47, s38, v47
    v_mul_f32 v48, s36, v48
    v_mul_f32 v49, s36, v49
    v_mul_f32 v50, s36, v50
    v_mul_f32 v51, s36, v51
    v_mul_f32 v52, s38, v52
    v_mul_f32 v53, s38, v53
    v_mul_f32 v54, s38, v54
    v_mul_f32 v55, s38, v55
    v_mul_f32 v56, s36, v56
    v_mul_f32 v57, s36, v57
    v_mul_f32 v58, s36, v58
    v_mul_f32 v59, s36, v59
    v_mul_f32 v60, s38, v60
    v_mul_f32 v61, s38, v61
    v_mul_f32 v62, s38, v62
    v_mul_f32 v63, s38, v63
    v_cvt_pk_bf16_f32 v120, v32, v40
    v_cvt_pk_bf16_f32 v121, v48, v56
    v_perm_b32 v96, v36, v120, s50
    v_perm_b32 v97, v44, v120, s51
    v_perm_b32 v98, v52, v121, s50
    v_perm_b32 v99, v60, v121, s51
    buffer_store_dwordx4 v[96:99], v116, s[4:7], s20 offen offset:0 sc1
    v_cvt_pk_bf16_f32 v120, v33, v41
    v_cvt_pk_bf16_f32 v121, v49, v57
    v_perm_b32 v100, v37, v120, s50
    v_perm_b32 v101, v45, v120, s51
    v_perm_b32 v102, v53, v121, s50
    v_perm_b32 v103, v61, v121, s51
    buffer_store_dwordx4 v[100:103], v116, s[4:7], s20 offen offset:512 sc1
    v_cvt_pk_bf16_f32 v120, v34, v42
    v_cvt_pk_bf16_f32 v121, v50, v58
    v_perm_b32 v104, v38, v120, s50
    v_perm_b32 v105, v46, v120, s51
    v_perm_b32 v106, v54, v121, s50
    v_perm_b32 v107, v62, v121, s51
    buffer_store_dwordx4 v[104:107], v116, s[4:7], s20 offen offset:1024 sc1
    v_cvt_pk_bf16_f32 v120, v35, v43
    v_cvt_pk_bf16_f32 v121, v51, v59
    v_perm_b32 v108, v39, v120, s50
    v_perm_b32 v109, v47, v120, s51
    v_perm_b32 v110, v55, v121, s50
    v_perm_b32 v111, v63, v121, s51
    buffer_store_dwordx4 v[108:111], v116, s[4:7], s20 offen offset:1536 sc1
    s_waitcnt vmcnt(0) lgkmcnt(0)
    s_add_u32 s3, s3, 8
    s_mov_b64 exec, 1
    v_mov_b32 v126, 23524
    v_mov_b32 v127, 1
    ds_add_u32 v126, v127
    s_mov_b32 s70, 0x4000000
sw_h2:
    ds_read_b32 v127, v126
    s_sub_u32 s70, s70, 1
    s_cbranch_scc1 sw_out_h2
    s_waitcnt lgkmcnt(0)
    v_cmp_gt_u32 vcc, s3, v127
    s_cbranch_vccz sw_out_h2
    s_sleep 1
    s_branch sw_h2
sw_out_h2:
    s_waitcnt lgkmcnt(0)
    s_mov_b64 exec, -1
    s_cmp_lg_u32 s25, 11
    s_cbranch_scc1 stored
    s_mov_b64 exec, 1
    v_mov_b32 v126, 23520
    s_mov_b32 s70, 0x4000000
lw_kept:
    ds_read_b32 v127, v126
    s_sub_u32 s70, s70, 1
    s_cbranch_scc1 lw_out_kept
    s_waitcnt lgkmcnt(0)
    v_cmp_gt_u32 vcc, 8, v127
    s_cbranch_vccz lw_out_kept
    s_sleep 2
    s_branch lw_kept
lw_out_kept:
    s_waitcnt lgkmcnt(0)
    s_mov_b64 exec, -1
    s_and_b32 s48, s2, 3
    s_lshl_b32 s49, s48, 6
    s_mov_b64 exec, 1
    v_mov_b32 v127, 1
    v_mov_b32 v126, s49
    buffer_atomic_add v127, v126, s[72:75], 0 offen offset:4 sc0 sc1
    s_mov_b64 exec, -1
    s_lshl_b32 s48, s48, 2
    s_add_u32 s48, s48, 0x3c0010
    s_waitcnt vmcnt(0)
    v_readfirstlane_b32 s49, v127
    v_lshlrev_b32 v126, 7, v113
    v_mov_b32 v127, 1
    s_and_b32 s49, s49, 63
    s_cmp_lg_u32 s49, 63
    s_cbranch_scc1 pub_done_1
    s_mov_b32 exec_hi, 0
    buffer_atomic_add v127, v126, s[12:15], s48 offen sc1
    s_mov_b64 exec, -1
pub_done_1:
    s_branch stored
second_half:
    s_waitcnt vmcnt(0) lgkmcnt(0)
    s_add_u32 s3, s3, 8
    s_mov_b64 exec, 1
    v_mov_b32 v126, 23524
    v_mov_b32 v127, 1
    ds_add_u32 v126, v127
    s_mov_b32 s70, 0x4000000
sw_h2b:
    ds_read_b32 v127, v126
    s_sub_u32 s70, s70, 1
    s_cbranch_scc1 sw_out_h2b
    s_waitcnt lgkmcnt(0)
    v_cmp_gt_u32 vcc, s3, v127
    s_cbranch_vccz sw_out_h2b
    s_sleep 1
    s_branch sw_h2b
sw_out_h2b:
    s_waitcnt lgkmcnt(0)
    s_mov_b64 exec, -1
    v_mul_f32 v0, s36, v0
    v_mul_f32 v1, s36, v1
    v_mul_f32 v2, s36, v2
    v_mul_f32 v3, s36, v3
    v_mul_f32 v4, s38, v4
    v_mul_f32 v5, s38, v5
    v_mul_f32 v6, s38, v6
    v_mul_f32 v7, s38, v7
    v_mul_f32 v8, s36, v8
    v_mul_f32 v9, s36, v9
    v_mul_f32 v10, s36, v10
    v_mul_f32 v11, s36, v11
    v_mul_f32 v12, s38, v12
    v_mul_f32 v13, s38, v13
    v_mul_f32 v14, s38, v14
    v_mul_f32 v15, s38, v15
    v_mul_f32 v16, s36, v16
    v_mul_f32 v17, s36, v17
    v_mul_f32 v18, s36, v18
    v_mul_f32 v19, s36, v19
    v_mul_f32 v20, s38, v20
    v_mul_f32 v21, s38, v21
    v_mul_f32 v22, s38, v22
    v_mul_f32 v23, s38, v23
    v_mul_f32 v24, s36, v24
    v_mul_f32 v25, s36, v25
    v_mul_f32 v26, s36, v26
    v_mul_f32 v27, s36, v27
    v_mul_f32 v28, s38, v28
    v_mul_f32 v29, s38, v29
    v_mul_f32 v30, s38, v30
    v_mul_f32 v31, s38, v31
    v_cvt_pk_bf16_f32 v120, v0, v8
    v_cvt_pk_bf16_f32 v121, v16, v24
    v_perm_b32 v96, v4, v120, s50
    v_perm_b32 v97, v12, v120, s51
    v_perm_b32 v98, v20, v121, s50
    v_perm_b32 v99, v28, v121, s51
    buffer_store_dwordx4 v[96:99], v116, s[4:7], 0 offen offset:0 sc1
    v_cvt_pk_bf16_f32 v120, v1, v9
    v_cvt_pk_bf16_f32 v121, v17, v25
    v_perm_b32 v100, v5, v120, s50
    v_perm_b32 v101, v13, v120, s51
    v_perm_b32 v102, v21, v121, s50
    v_perm_b32 v103, v29, v121, s51
    buffer_store_dwordx4 v[100:103], v116, s[4:7], 0 offen offset:512 sc1
    v_cvt_pk_bf16_f32 v120, v2, v10
    v_cvt_pk_bf16_f32 v121, v18, v26
    v_perm_b32 v104, v6, v120, s50
    v_perm_b32 v105, v14, v120, s51
    v_perm_b32 v106, v22, v121, s50
    v_perm_b32 v107, v30, v121, s51
    buffer_store_dwordx4 v[104:107], v116, s[4:7], 0 offen offset:1024 sc1
    v_cvt_pk_bf16_f32 v120, v3, v11
    v_cvt_pk_bf16_f32 v121, v19, v27
    v_perm_b32 v108, v7, v120, s50
    v_perm_b32 v109, v15, v120, s51
    v_perm_b32 v110, v23, v121, s50
    v_perm_b32 v111, v31, v121, s51
    buffer_store_dwordx4 v[108:111], v116, s[4:7], 0 offen offset:1536 sc1
    v_mul_f32 v32, s36, v32
    v_mul_f32 v33, s36, v33
    v_mul_f32 v34, s36, v34
    v_mul_f32 v35, s36, v35
    v_mul_f32 v36, s38, v36
    v_mul_f32 v37, s38, v37
    v_mul_f32 v38, s38, v38
    v_mul_f32 v39, s38, v39
    v_mul_f32 v40, s36, v40
    v_mul_f32 v41, s36, v41
    v_mul_f32 v42, s36, v42
    v_mul_f32 v43, s36, v43
    v_mul_f32 v44, s38, v44
    v_mul_f32 v45, s38, v45
    v_mul_f32 v46, s38, v46
    v_mul_f32 v47, s38, v47
    v_mul_f32 v48, s36, v48
    v_mul_f32 v49, s36, v49
    v_mul_f32 v50, s36, v50
    v_mul_f32 v51, s36, v51
    v_mul_f32 v52, s38, v52
    v_mul_f32 v53, s38, v53
    v_mul_f32 v54, s38, v54
    v_mul_f32 v55, s38, v55
    v_mul_f32 v56, s36, v56
    v_mul_f32 v57, s36, v57
    v_mul_f32 v58, s36, v58
    v_mul_f32 v59, s36, v59
    v_mul_f32 v60, s38, v60
    v_mul_f32 v61, s38, v61
    v_mul_f32 v62, s38, v62
    v_mul_f32 v63, s38, v63
    v_cvt_pk_bf16_f32 v120, v32, v40
    v_cvt_pk_bf16_f32 v121, v48, v56
    v_perm_b32 v96, v36, v120, s50
    v_perm_b32 v97, v44, v120, s51
    v_perm_b32 v98, v52, v121, s50
    v_perm_b32 v99, v60, v121, s51
    buffer_store_dwordx4 v[96:99], v116, s[4:7], s20 offen offset:0 sc1
    v_cvt_pk_bf16_f32 v120, v33, v41
    v_cvt_pk_bf16_f32 v121, v49, v57
    v_perm_b32 v100, v37, v120, s50
    v_perm_b32 v101, v45, v120, s51
    v_perm_b32 v102, v53, v121, s50
    v_perm_b32 v103, v61, v121, s51
    buffer_store_dwordx4 v[100:103], v116, s[4:7], s20 offen offset:512 sc1
    v_cvt_pk_bf16_f32 v120, v34, v42
    v_cvt_pk_bf16_f32 v121, v50, v58
    v_perm_b32 v104, v38, v120, s50
    v_perm_b32 v105, v46, v120, s51
    v_perm_b32 v106, v54, v121, s50
    v_perm_b32 v107, v62, v121, s51
    buffer_store_dwordx4 v[104:107], v116, s[4:7], s20 offen offset:1024 sc1
    v_cvt_pk_bf16_f32 v120, v35, v43
    v_cvt_pk_bf16_f32 v121, v51, v59
    v_perm_b32 v108, v39, v120, s50
    v_perm_b32 v109, v47, v120, s51
    v_perm_b32 v110, v55, v121, s50
    v_perm_b32 v111, v63, v121, s51
    buffer_store_dwordx4 v[108:111], v116, s[4:7], s20 offen offset:1536 sc1
stored:
    s_mov_b32 s6, 0xc35200
b_part:
    v_and_b32 v120, 15, v113
    v_lshrrev_b32 v121, 4, v113
    v_lshrrev_b32 v96, 3, v120
    v_lshl_add_u32 v96, v121, 1, v96
    v_mul_u32_u24 v114, 1088, v96
    s_lshr_b32 s48, s28, 2
    s_lshl_b32 s48, s48, 8
    s_add_u32 s48, s48, 23616
    v_add_u32 v114, s48, v114
    v_and_b32 v96, 3, v120
    v_lshl_add_u32 v114, v96, 3, v114
    v_bfe_u32 v96, v120, 2, 1
    v_mul_u32_u24 v97, 480, v96
    v_add_u32 v115, v97, v114
    v_mul_u32_u24 v97, 544, v96
    v_add_u32 v114, v97, v114
    ds_read_b64_tr_b16 v[96:97], v114 offset:0
    ds_read_b64_tr_b16 v[98:99], v114 offset:8704
    ds_read_b64_tr_b16 v[100:101], v115 offset:32
    ds_read_b64_tr_b16 v[102:103], v115 offset:8736
    ds_read_b64_tr_b16 v[104:105], v114 offset:64
    ds_read_b64_tr_b16 v[106:107], v114 offset:8768
    ds_read_b64_tr_b16 v[108:109], v115 offset:96
    ds_read_b64_tr_b16 v[110:111], v115 offset:8800
    s_waitcnt lgkmcnt(6)
    v_mfma_f32_16x16x32_bf16 v[0:3], v[64:67], v[96:99], 0
    v_mfma_f32_16x16x32_bf16 v[32:35], v[80:83], v[96:99], 0
    ds_read_b64_tr_b16 v[96:97], v114 offset:128
    ds_read_b64_tr_b16 v[98:99], v114 offset:8832
    s_waitcnt lgkmcnt(6)
    v_mfma_f32_16x16x32_bf16 v[4:7], v[64:67], v[100:103], 0
    v_mfma_f32_16x16x32_bf16 v[36:39], v[80:83], v[100:103], 0
    ds_read_b64_tr_b16 v[100:101], v115 offset:160
    ds_read_b64_tr_b16 v[102:103], v115 offset:8864
    s_waitcnt lgkmcnt(6)
    v_mfma_f32_16x16x32_bf16 v[8:11], v[64:67], v[104:107], 0
    v_mfma_f32_16x16x32_bf16 v[40:43], v[80:83], v[104:107], 0
    ds_read_b64_tr_b16 v[104:105], v114 offset:192
    ds_read_b64_tr_b16 v[106:107], v114 offset:8896
    s_waitcnt lgkmcnt(6)
    v_mfma_f32_16x16x32_bf16 v[12:15], v[64:67], v[108:111], 0
    v_mfma_f32_16x16x32_bf16 v[44:47], v[80:83], v[108:111], 0
    ds_read_b64_tr_b16 v[108:109], v115 offset:224
    ds_read_b64_tr_b16 v[110:111], v115 offset:8928
    s_waitcnt lgkmcnt(6)
    v_mfma_f32_16x16x32_bf16 v[16:19], v[64:67], v[96:99], 0
    v_mfma_f32_16x16x32_bf16 v[48:51], v[80:83], v[96:99], 0
    ds_read_b64_tr_b16 v[96:97], v114 offset:17408
    ds_read_b64_tr_b16 v[98:99], v114 offset:26112
    s_waitcnt lgkmcnt(6)
    v_mfma_f32_16x16x32_bf16 v[20:23], v[64:67], v[100:103], 0
    v_mfma_f32_16x16x32_bf16 v[52:55], v[80:83], v[100:103], 0
    ds_read_b64_tr_b16 v[100:101], v115 offset:17440
    ds_read_b64_tr_b16 v[102:103], v115 offset:26144
    s_waitcnt lgkmcnt(6)
    v_mfma_f32_16x16x32_bf16 v[24:27], v[64:67], v[104:107], 0
    v_mfma_f32_16x16x32_bf16 v[56:59], v[80:83], v[104:107], 0
    ds_read_b64_tr_b16 v[104:105], v114 offset:17472
    ds_read_b64_tr_b16 v[106:107], v114 offset:26176
    s_waitcnt lgkmcnt(6)
    v_mfma_f32_16x16x32_bf16 v[28:31], v[64:67], v[108:111], 0
    v_mfma_f32_16x16x32_bf16 v[60:63], v[80:83], v[108:111], 0
    ds_read_b64_tr_b16 v[108:109], v115 offset:17504
    ds_read_b64_tr_b16 v[110:111], v115 offset:26208
    s_waitcnt lgkmcnt(6)
    v_mfma_f32_16x16x32_bf16 v[0:3], v[68:71], v[96:99], v[0:3]
    v_mfma_f32_16x16x32_bf16 v[32:35], v[84:87], v[96:99], v[32:35]
    ds_read_b64_tr_b16 v[96:97], v114 offset:17536
    ds_read_b64_tr_b16 v[98:99], v114 offset:26240
    s_waitcnt lgkmcnt(6)
    v_mfma_f32_16x16x32_bf16 v[4:7], v[68:71], v[100:103], v[4:7]
    v_mfma_f32_16x16x32_bf16 v[36:39], v[84:87], v[100:103], v[36:39]
    ds_read_b64_tr_b16 v[100:101], v115 offset:17568
    ds_read_b64_tr_b16 v[102:103], v115 offset:26272
    s_waitcnt lgkmcnt(6)
    v_mfma_f32_16x16x32_bf16 v[8:11], v[68:71], v[104:107], v[8:11]
    v_mfma_f32_16x16x32_bf16 v[40:43], v[84:87], v[104:107], v[40:43]
    ds_read_b64_tr_b16 v[104:105], v114 offset:17600
    ds_read_b64_tr_b16 v[106:107], v114 offset:26304
    s_waitcnt lgkmcnt(6)
    v_mfma_f32_16x16x32_bf16 v[12:15], v[68:71], v[108:111], v[12:15]
    v_mfma_f32_16x16x32_bf16 v[44:47], v[84:87], v[108:111], v[44:47]
    ds_read_b64_tr_b16 v[108:109], v115 offset:17632
    ds_read_b64_tr_b16 v[110:111], v115 offset:26336
    s_waitcnt lgkmcnt(6)
    v_mfma_f32_16x16x32_bf16 v[16:19], v[68:71], v[96:99], v[16:19]
    v_mfma_f32_16x16x32_bf16 v[48:51], v[84:87], v[96:99], v[48:51]
    ds_read_b64_tr_b16 v[96:97], v114 offset:34816
    ds_read_b64_tr_b16 v[98:99], v114 offset:43520
    s_waitcnt lgkmcnt(6)
    v_mfma_f32_16x16x32_bf16 v[20:23], v[68:71], v[100:103], v[20:23]
    v_mfma_f32_16x16x32_bf16 v[52:55], v[84:87], v[100:103], v[52:55]
    ds_read_b64_tr_b16 v[100:101], v115 offset:34848
    ds_read_b64_tr_b16 v[102:103], v115 offset:43552
    s_waitcnt lgkmcnt(6)
    v_mfma_f32_16x16x32_bf16 v[24:27], v[68:71], v[104:107], v[24:27]
    v_mfma_f32_16x16x32_bf16 v[56:59], v[84:87], v[104:107], v[56:59]
    ds_read_b64_tr_b16 v[104:105], v114 offset:34880
    ds_read_b64_tr_b16 v[106:107], v114 offset:43584
    s_waitcnt lgkmcnt(6)
    v_mfma_f32_16x16x32_bf16 v[28:31], v[68:71], v[108:111], v[28:31]
    v_mfma_f32_16x16x32_bf16 v[60:63], v[84:87], v[108:111], v[60:63]
    ds_read_b64_tr_b16 v[108:109], v115 offset:34912
    ds_read_b64_tr_b16 v[110:111], v115 offset:43616
    s_waitcnt lgkmcnt(6)
    v_mfma_f32_16x16x32_bf16 v[0:3], v[72:75], v[96:99], v[0:3]
    v_mfma_f32_16x16x32_bf16 v[32:35], v[88:91], v[96:99], v[32:35]
    ds_read_b64_tr_b16 v[96:97], v114 offset:34944
    ds_read_b64_tr_b16 v[98:99], v114 offset:43648
    s_waitcnt lgkmcnt(6)
    v_mfma_f32_16x16x32_bf16 v[4:7], v[72:75], v[100:103], v[4:7]
    v_mfma_f32_16x16x32_bf16 v[36:39], v[88:91], v[100:103], v[36:39]
    ds_read_b64_tr_b16 v[100:101], v115 offset:34976
    ds_read_b64_tr_b16 v[102:103], v115 offset:43680
    s_waitcnt lgkmcnt(6)
    v_mfma_f32_16x16x32_bf16 v[8:11], v[72:75], v[104:107], v[8:11]
    v_mfma_f32_16x16x32_bf16 v[40:43], v[88:91], v[104:107], v[40:43]
    ds_read_b64_tr_b16 v[104:105], v114 offset:35008
    ds_read_b64_tr_b16 v[106:107], v114 offset:43712
    s_waitcnt lgkmcnt(6)
    v_mfma_f32_16x16x32_bf16 v[12:15], v[72:75], v[108:111], v[12:15]
    v_mfma_f32_16x16x32_bf16 v[44:47], v[88:91], v[108:111], v[44:47]
    ds_read_b64_tr_b16 v[108:109], v115 offset:35040
    ds_read_b64_tr_b16 v[110:111], v115 offset:43744
    s_waitcnt lgkmcnt(6)
    v_mfma_f32_16x16x32_bf16 v[16:19], v[72:75], v[96:99], v[16:19]
    v_mfma_f32_16x16x32_bf16 v[48:51], v[88:91], v[96:99], v[48:51]
    ds_read_b64_tr_b16 v[96:97], v114 offset:52224
    ds_read_b64_tr_b16 v[98:99], v114 offset:60928
    s_waitcnt lgkmcnt(6)
    v_mfma_f32_16x16x32_bf16 v[20:23], v[72:75], v[100:103], v[20:23]
    v_mfma_f32_16x16x32_bf16 v[52:55], v[88:91], v[100:103], v[52:55]
    ds_read_b64_tr_b16 v[100:101], v115 offset:52256
    ds_read_b64_tr_b16 v[102:103], v115 offset:60960
    s_waitcnt lgkmcnt(6)
    v_mfma_f32_16x16x32_bf16 v[24:27], v[72:75], v[104:107], v[24:27]
    v_mfma_f32_16x16x32_bf16 v[56:59], v[88:91], v[104:107], v[56:59]
    ds_read_b64_tr_b16 v[104:105], v114 offset:52288
    ds_read_b64_tr_b16 v[106:107], v114 offset:60992
    s_waitcnt lgkmcnt(6)
    v_mfma_f32_16x16x32_bf16 v[28:31], v[72:75], v[108:111], v[28:31]
    v_mfma_f32_16x16x32_bf16 v[60:63], v[88:91], v[108:111], v[60:63]
    ds_read_b64_tr_b16 v[108:109], v115 offset:52320
    ds_read_b64_tr_b16 v[110:111], v115 offset:61024
    s_waitcnt lgkmcnt(6)
    v_mfma_f32_16x16x32_bf16 v[0:3], v[76:79], v[96:99], v[0:3]
    v_mfma_f32_16x16x32_bf16 v[32:35], v[92:95], v[96:99], v[32:35]
    ds_read_b64_tr_b16 v[96:97], v114 offset:52352
    ds_read_b64_tr_b16 v[98:99], v114 offset:61056
    s_waitcnt lgkmcnt(6)
    v_mfma_f32_16x16x32_bf16 v[4:7], v[76:79], v[100:103], v[4:7]
    v_mfma_f32_16x16x32_bf16 v[36:39], v[92:95], v[100:103], v[36:39]
    ds_read_b64_tr_b16 v[100:101], v115 offset:52384
    ds_read_b64_tr_b16 v[102:103], v115 offset:61088
    s_waitcnt lgkmcnt(6)
    v_mfma_f32_16x16x32_bf16 v[8:11], v[76:79], v[104:107], v[8:11]
    v_mfma_f32_16x16x32_bf16 v[40:43], v[92:95], v[104:107], v[40:43]
    ds_read_b64_tr_b16 v[104:105], v114 offset:52416
    ds_read_b64_tr_b16 v[106:107], v114 offset:61120
    s_waitcnt lgkmcnt(6)
    v_mfma_f32_16x16x32_bf16 v[12:15], v[76:79], v[108:111], v[12:15]
    v_mfma_f32_16x16x32_bf16 v[44:47], v[92:95], v[108:111], v[44:47]
    ds_read_b64_tr_b16 v[108:109], v115 offset:52448
    ds_read_b64_tr_b16 v[110:111], v115 offset:61152
    s_waitcnt lgkmcnt(6)
    v_mfma_f32_16x16x32_bf16 v[16:19], v[76:79], v[96:99], v[16:19]
    v_mfma_f32_16x16x32_bf16 v[48:51], v[92:95], v[96:99], v[48:51]
    s_waitcnt lgkmcnt(4)
    v_mfma_f32_16x16x32_bf16 v[20:23], v[76:79], v[100:103], v[20:23]
    v_mfma_f32_16x16x32_bf16 v[52:55], v[92:95], v[100:103], v[52:55]
    s_waitcnt lgkmcnt(2)
    v_mfma_f32_16x16x32_bf16 v[24:27], v[76:79], v[104:107], v[24:27]
    v_mfma_f32_16x16x32_bf16 v[56:59], v[92:95], v[104:107], v[56:59]
    s_waitcnt lgkmcnt(0)
    v_mfma_f32_16x16x32_bf16 v[28:31], v[76:79], v[108:111], v[28:31]
    v_mfma_f32_16x16x32_bf16 v[60:63], v[92:95], v[108:111], v[60:63]
    v_and_b32 v120, 15, v113
    v_lshrrev_b32 v121, 4, v113
    s_and_b32 s48, s28, 3
    s_lshl_b32 s48, s48, 5
    v_lshl_add_u32 v116, v121, 2, s48
    v_mul_u32_u24 v118, 528, v116
    v_lshl_add_u32 v118, v120, 4, v118
    s_lshr_b32 s48, s28, 2
    s_lshl_b32 s48, s48, 8
    v_add_u32 v118, s48, v118
    s_mov_b32 s36, 0x3fb8aa3b
    s_mov_b32 s37, 0x3fb8aa3b
    s_mov_b32 s38, 0x25b8aa3b
    s_mov_b32 s39, 0x25b8aa3b
    v_mul_f32 v0, s36, v0
    v_mul_f32 v1, s36, v1
    v_mul_f32 v2, s36, v2
    v_mul_f32 v3, s36, v3
    v_mul_f32 v4, s38, v4
    v_mul_f32 v5, s38, v5
    v_mul_f32 v6, s38, v6
    v_mul_f32 v7, s38, v7
    v_mul_f32 v8, s36, v8
    v_mul_f32 v9, s36, v9
    v_mul_f32 v10, s36, v10
    v_mul_f32 v11, s36, v11
    v_mul_f32 v12, s38, v12
    v_mul_f32 v13, s38, v13
    v_mul_f32 v14, s38, v14
    v_mul_f32 v15, s38, v15
    v_mul_f32 v16, s36, v16
    v_mul_f32 v17, s36, v17
    v_mul_f32 v18, s36, v18
    v_mul_f32 v19, s36, v19
    v_mul_f32 v20, s38, v20
    v_mul_f32 v21, s38, v21
    v_mul_f32 v22, s38, v22
    v_mul_f32 v23, s38, v23
    v_mul_f32 v24, s36, v24
    v_mul_f32 v25, s36, v25
    v_mul_f32 v26, s36, v26
    v_mul_f32 v27, s36, v27
    v_mul_f32 v28, s38, v28
    v_mul_f32 v29, s38, v29
    v_mul_f32 v30, s38, v30
    v_mul_f32 v31, s38, v31
    v_cvt_pk_bf16_f32 v64, v0, v8
    v_cvt_pk_bf16_f32 v65, v16, v24
    v_cvt_pk_bf16_f32 v66, v4, v12
    v_cvt_pk_bf16_f32 v67, v20, v28
    v_cvt_pk_bf16_f32 v68, v1, v9
    v_cvt_pk_bf16_f32 v69, v17, v25
    v_cvt_pk_bf16_f32 v70, v5, v13
    v_cvt_pk_bf16_f32 v71, v21, v29
    v_cvt_pk_bf16_f32 v72, v2, v10
    v_cvt_pk_bf16_f32 v73, v18, v26
    v_cvt_pk_bf16_f32 v74, v6, v14
    v_cvt_pk_bf16_f32 v75, v22, v30
    v_cvt_pk_bf16_f32 v76, v3, v11
    v_cvt_pk_bf16_f32 v77, v19, v27
    v_cvt_pk_bf16_f32 v78, v7, v15
    v_cvt_pk_bf16_f32 v79, v23, v31
    v_mul_f32 v32, s36, v32
    v_mul_f32 v33, s36, v33
    v_mul_f32 v34, s36, v34
    v_mul_f32 v35, s36, v35
    v_mul_f32 v36, s38, v36
    v_mul_f32 v37, s38, v37
    v_mul_f32 v38, s38, v38
    v_mul_f32 v39, s38, v39
    v_mul_f32 v40, s36, v40
    v_mul_f32 v41, s36, v41
    v_mul_f32 v42, s36, v42
    v_mul_f32 v43, s36, v43
    v_mul_f32 v44, s38, v44
    v_mul_f32 v45, s38, v45
    v_mul_f32 v46, s38, v46
    v_mul_f32 v47, s38, v47
    v_mul_f32 v48, s36, v48
    v_mul_f32 v49, s36, v49
    v_mul_f32 v50, s36, v50
    v_mul_f32 v51, s36, v51
    v_mul_f32 v52, s38, v52
    v_mul_f32 v53, s38, v53
    v_mul_f32 v54, s38, v54
    v_mul_f32 v55, s38, v55
    v_mul_f32 v56, s36, v56
    v_mul_f32 v57, s36, v57
    v_mul_f32 v58, s36, v58
    v_mul_f32 v59, s36, v59
    v_mul_f32 v60, s38, v60
    v_mul_f32 v61, s38, v61
    v_mul_f32 v62, s38, v62
    v_mul_f32 v63, s38, v63
    v_cvt_pk_bf16_f32 v80, v32, v40
    v_cvt_pk_bf16_f32 v81, v48, v56
    v_cvt_pk_bf16_f32 v82, v36, v44
    v_cvt_pk_bf16_f32 v83, v52, v60
    v_cvt_pk_bf16_f32 v84, v33, v41
    v_cvt_pk_bf16_f32 v85, v49, v57
    v_cvt_pk_bf16_f32 v86, v37, v45
    v_cvt_pk_bf16_f32 v87, v53, v61
    v_cvt_pk_bf16_f32 v88, v34, v42
    v_cvt_pk_bf16_f32 v89, v50, v58
    v_cvt_pk_bf16_f32 v90, v38, v46
    v_cvt_pk_bf16_f32 v91, v54, v62
    v_cvt_pk_bf16_f32 v92, v35, v43
    v_cvt_pk_bf16_f32 v93, v51, v59
    v_cvt_pk_bf16_f32 v94, v39, v47
    v_cvt_pk_bf16_f32 v95, v55, v63
    s_waitcnt lgkmcnt(0)
    s_add_u32 s3, s3, 8
    s_mov_b64 exec, 1
    v_mov_b32 v126, 23524
    v_mov_b32 v127, 1
    ds_add_u32 v126, v127
    s_mov_b32 s70, 0x4000000
sw_h3:
    ds_read_b32 v127, v126
    s_sub_u32 s70, s70, 1
    s_cbranch_scc1 sw_out_h3
    s_waitcnt lgkmcnt(0)
    v_cmp_gt_u32 vcc, s3, v127
    s_cbranch_vccz sw_out_h3
    s_sleep 1
    s_branch sw_h3
sw_out_h3:
    s_waitcnt lgkmcnt(0)
    s_mov_b64 exec, -1
    v_cmpx_gt_u32 vcc, 100, v116
    ds_write_b128 v118, v[64:67] offset:23600
    ds_write_b128 v118, v[68:71] offset:24128
    ds_write_b128 v118, v[72:75] offset:24656
    ds_write_b128 v118, v[76:79] offset:25184
    v_cmpx_gt_u32 vcc, 84, v116
    ds_write_b128 v118, v[80:83] offset:32048
    ds_write_b128 v118, v[84:87] offset:32576
    ds_write_b128 v118, v[88:91] offset:33104
    ds_write_b128 v118, v[92:95] offset:33632
    s_mov_b64 exec, -1
    s_mov_b32 s38, 0x3f80
    s_mov_b32 s32, 0x3f800000
    s_mov_b32 s39, 76800
    s_mov_b32 s40, 0x20000000
    s_mov_b32 s41, 0x20000000
    s_mov_b32 s42, 0x3f800000
    s_mov_b32 s43, 0x3f800000
    s_mov_b32 s44, 0x1fb17218
    s_mov_b32 s45, 0x1fb17218
    s_mov_b32 s46, 0x3f800000
    s_mov_b32 s47, 0x3f800000
    v_mov_b32 v118, 21312
    v_and_b32 v104, 15, v113
    v_lshrrev_b32 v116, 4, v113
    v_lshlrev_b32 v115, 5, v104
    v_add_u32 v115, 18496, v115
    v_lshlrev_b32 v105, 3, v116
    v_lshlrev_b32 v104, 4, v104
    v_lshlrev_b32 v116, 2, v116
    v_add_u32 v116, 22368, v116
    s_mov_b64 s[22:23], s[64:65]
lut_job:
    s_bfe_u32 s50, s22, 0x50007
    s_cmp_eq_u32 s50, 0
    s_cbranch_scc1 lut_done
    s_and_b32 s51, s22, 0x7f
    s_lshl_b32 s48, s51, 25
    s_or_b32 s48, s48, 0x8000
    v_lshl_add_u32 v72, v113, 19, s48
    s_lshl_b32 s49, s51, 10
    s_add_u32 s49, s49, 76800
    v_lshl_add_u32 v80, v113, 4, s49
    v_add_u32 v73, 0x10000, v72
    v_add_u32 v74, 0x20000, v72
    v_add_u32 v75, 0x30000, v72
    v_add_u32 v76, 0x40000, v72
    v_add_u32 v77, 0x50000, v72
    v_add_u32 v78, 0x60000, v72
    v_add_u32 v79, 0x70000, v72
    s_and_b32 s48, s51, 63
    s_sub_u32 s48, s48, 16
    s_cmp_lt_u32 s48, 5
    s_cbranch_scc1 lut_full
    s_mov_b32 s49, 0x59317218
    s_cmp_lt_i32 s48, 0
    s_cselect_b32 s48, 0x58b17218, s49
    s_mov_b32 s49, s48
    v_pk_mul_f32 v[72:73], v[72:73], s[48:49]
    v_pk_mul_f32 v[74:75], v[74:75], s[48:49]
    v_pk_mul_f32 v[76:77], v[76:77], s[48:49]
    v_pk_mul_f32 v[78:79], v[78:79], s[48:49]
    s_branch lut_pack
lut_full:
    s_mov_b32 s48, 0x59800000
    s_mov_b32 s49, s48
    v_pk_mul_f32 v[72:73], v[72:73], s[48:49]
    v_pk_mul_f32 v[74:75], v[74:75], s[48:49]
    v_pk_mul_f32 v[76:77], v[76:77], s[48:49]
    v_pk_mul_f32 v[78:79], v[78:79], s[48:49]
    s_mov_b32 s48, 0x3f317218
    s_mov_b32 s49, s48
    v_exp_f32 v88, -v72
    v_exp_f32 v89, -v73
    v_exp_f32 v90, -v74
    v_exp_f32 v91, -v75
    v_exp_f32 v92, -v76
    v_exp_f32 v93, -v77
    v_exp_f32 v94, -v78
    v_exp_f32 v95, -v79
    v_pk_mul_f32 v[72:73], v[72:73], s[48:49]
    v_pk_add_f32 v[88:89], v[88:89], s[42:43]
    v_pk_mul_f32 v[74:75], v[74:75], s[48:49]
    v_pk_add_f32 v[90:91], v[90:91], s[42:43]
    v_pk_mul_f32 v[76:77], v[76:77], s[48:49]
    v_pk_add_f32 v[92:93], v[92:93], s[42:43]
    v_pk_mul_f32 v[78:79], v[78:79], s[48:49]
    v_pk_add_f32 v[94:95], v[94:95], s[42:43]
    v_rcp_f32 v88, v88
    v_rcp_f32 v89, v89
    v_rcp_f32 v90, v90
    v_rcp_f32 v91, v91
    v_rcp_f32 v92, v92
    v_rcp_f32 v93, v93
    v_rcp_f32 v94, v94
    v_rcp_f32 v95, v95
    v_pk_mul_f32 v[72:73], v[72:73], v[88:89]
    v_pk_mul_f32 v[74:75], v[74:75], v[90:91]
    v_pk_mul_f32 v[76:77], v[76:77], v[92:93]
    v_pk_mul_f32 v[78:79], v[78:79], v[94:95]
lut_pack:
    v_cvt_pk_bf16_f32 v82, v72, v73
    v_cvt_pk_bf16_f32 v83, v74, v75
    v_cvt_pk_bf16_f32 v84, v76, v77
    v_cvt_pk_bf16_f32 v85, v78, v79
    s_bitcmp1_b32 s22, 12
    s_cselect_b32 s48, 0x02000200, 0
    ds_write_b128 v80, v[82:85] offset:0
    s_cmp_eq_u32 s50, 1
    s_cbranch_scc1 lut_next
    v_add_u32 v86, s48, v82
    v_add_u32 v87, s48, v83
    v_add_u32 v88, s48, v84
    v_add_u32 v89, s48, v85
    ds_write_b128 v80, v[86:89] offset:1024
    s_cmp_eq_u32 s50, 2
    s_cbranch_scc1 lut_next
    v_add_u32 v82, s48, v86
    v_add_u32 v83, s48, v87
    v_add_u32 v84, s48, v88
    v_add_u32 v85, s48, v89
    ds_write_b128 v80, v[82:85] offset:2048
    s_cmp_eq_u32 s50, 3
    s_cbranch_scc1 lut_next
    v_add_u32 v86, s48, v82
    v_add_u32 v87, s48, v83
    v_add_u32 v88, s48, v84
    v_add_u32 v89, s48, v85
    ds_write_b128 v80, v[86:89] offset:3072
    s_cmp_eq_u32 s50, 4
    s_cbranch_scc1 lut_next
    v_add_u32 v82, s48, v86
    v_add_u32 v83, s48, v87
    v_add_u32 v84, s48, v88
    v_add_u32 v85, s48, v89
    ds_write_b128 v80, v[82:85] offset:4096
    s_cmp_eq_u32 s50, 5
    s_cbranch_scc1 lut_next
    v_add_u32 v86, s48, v82
    v_add_u32 v87, s48, v83
    v_add_u32 v88, s48, v84
    v_add_u32 v89, s48, v85
    ds_write_b128 v80, v[86:89] offset:5120
    s_cmp_eq_u32 s50, 6
    s_cbranch_scc1 lut_next
    v_add_u32 v82, s48, v86
    v_add_u32 v83, s48, v87
    v_add_u32 v84, s48, v88
    v_add_u32 v85, s48, v89
    ds_write_b128 v80, v[82:85] offset:6144
    s_cmp_eq_u32 s50, 7
    s_cbranch_scc1 lut_next
    v_add_u32 v86, s48, v82
    v_add_u32 v87, s48, v83
    v_add_u32 v88, s48, v84
    v_add_u32 v89, s48, v85
    ds_write_b128 v80, v[86:89] offset:7168
    s_cmp_eq_u32 s50, 8
    s_cbranch_scc1 lut_next
    v_add_u32 v82, s48, v86
    v_add_u32 v83, s48, v87
    v_add_u32 v84, s48, v88
    v_add_u32 v85, s48, v89
    ds_write_b128 v80, v[82:85] offset:8192
    s_cmp_eq_u32 s50, 9
    s_cbranch_scc1 lut_next
    v_add_u32 v86, s48, v82
    v_add_u32 v87, s48, v83
    v_add_u32 v88, s48, v84
    v_add_u32 v89, s48, v85
    ds_write_b128 v80, v[86:89] offset:9216
    s_cmp_eq_u32 s50, 10
    s_cbranch_scc1 lut_next
    v_add_u32 v82, s48, v86
    v_add_u32 v83, s48, v87
    v_add_u32 v84, s48, v88
    v_add_u32 v85, s48, v89
    ds_write_b128 v80, v[82:85] offset:10240
    s_cmp_eq_u32 s50, 11
    s_cbranch_scc1 lut_next
    v_add_u32 v86, s48, v82
    v_add_u32 v87, s48, v83
    v_add_u32 v88, s48, v84
    v_add_u32 v89, s48, v85
    ds_write_b128 v80, v[86:89] offset:11264
lut_next:
    s_lshr_b64 s[22:23], s[22:23], 16
    s_branch lut_job
lut_done:
    s_cmp_lg_u32 s25, 15
    s_cbranch_scc1 joined
    s_cmp_lg_u32 s26, 0
    s_cbranch_scc1 joined
    v_mov_b32 v126, 0
    ds_read_b32 v127, v126 offset:23588
    s_waitcnt lgkmcnt(0)
    v_cmp_ne_u32 vcc, 0, v127
    s_cbranch_vccnz joined
    v_lshlrev_b32 v126, 2, v113
    s_lshr_b32 s48, s2, 3
    s_lshl_b32 s48, s48, 7
    s_add_u32 s48, s48, 0x3c0010
    s_mov_b32 s49, 0x40000
    s_mov_b64 exec, 15
    ds_read_b32 v119, v126 offset:23552
aw_1:
    v_mov_b32 v127, 0
    buffer_atomic_add v127, v126, s[12:15], s48 offen sc0 sc1
    s_sub_u32 s49, s49, 1
    s_cbranch_scc1 aw_done_1
    s_waitcnt vmcnt(0) lgkmcnt(0)
    v_cmp_eq_u32 vcc, v119, v127
    s_cbranch_vccz aw_done_1
    s_sleep 4
    s_branch aw_1
aw_done_1:
    s_waitcnt vmcnt(0) lgkmcnt(0)
    s_mov_b64 exec, -1
    s_branch joined
next_round:
    s_waitcnt vmcnt(0) lgkmcnt(0)
    s_barrier
    s_cmp_lt_u32 s25, 8
    s_cbranch_scc1 chain_init
    s_sub_u32 s28, s25, 8
    v_lshrrev_b32 v120, 5, v113
    v_lshlrev_b32 v121, 1, v120
    v_and_b32 v117, 31, v113
    v_xor_b32 v117, v117, v121
    v_lshlrev_b32 v117, 4, v117
    v_lshl_add_u32 v117, v120, 9, v117
    s_and_b32 s30, s28, 3
    s_lshl_b32 s30, s30, 12
    s_lshr_b32 s48, s28, 2
    s_lshl_b32 s48, s48, 11
    s_add_u32 s30, s30, s48
    s_mul_i32 s31, s28, 2176
    s_lshr_b32 s29, s2, 2
    s_and_b32 s29, s29, 2
    s_mul_i32 s51, s24, 98
    s_and_b32 s48, s28, 3
    s_lshl_b32 s48, s48, 5
    s_add_u32 s51, s51, s48
    v_and_b32 v120, 15, v113
    v_lshrrev_b32 v121, 4, v113
    v_xor_b32 v118, v120, v121
    v_lshlrev_b32 v118, 4, v118
    v_lshl_add_u32 v118, v121, 8, v118
    s_mov_b32 s32, s52
    s_and_b32 s33, s53, 0xffff
    s_mov_b32 s34, 0x20200
    s_mov_b32 s35, 0x20000
    s_mul_i32 s50, s24, 25088
    s_add_u32 s49, s28, 0
    s_mul_i32 s48, s49, 1088
    s_add_u32 m0, s48, 23616
    s_lshl_b32 s49, s49, 10
    s_add_u32 s49, s49, s50
    buffer_load_dwordx4 v118, s[8:11], s49 offen lds
    s_add_u32 s49, s28, 8
    s_mul_i32 s48, s49, 1088
    s_add_u32 m0, s48, 23616
    s_lshl_b32 s49, s49, 10
    s_add_u32 s49, s49, s50
    buffer_load_dwordx4 v118, s[8:11], s49 offen lds
    s_add_u32 s49, s28, 16
    s_mul_i32 s48, s49, 1088
    s_add_u32 m0, s48, 23616
    s_lshl_b32 s49, s49, 10
    s_add_u32 s49, s49, s50
    buffer_load_dwordx4 v118, s[8:11], s49 offen lds
    s_cmp_lg_u32 s25, 8
    s_cbranch_scc1 x_issuedr
    s_add_u32 s49, s28, 24
    s_mul_i32 s48, s49, 1088
    s_add_u32 m0, s48, 23616
    s_lshl_b32 s49, s49, 10
    s_add_u32 s49, s49, s50
    buffer_load_dwordx4 v118, s[8:11], s49 offen lds
x_issuedr:
    v_and_b32 v120, 15, v113
    v_lshrrev_b32 v121, 4, v113
    v_lshrrev_b32 v96, 2, v120
    v_mul_u32_u24 v96, 1088, v96
    v_and_b32 v97, 3, v120
    v_lshl_add_u32 v96, v97, 8, v96
    v_xor_b32 v97, v97, v121
    v_lshl_add_u32 v96, v97, 4, v96
    s_and_b32 s48, s28, 3
    s_mul_i32 s48, s48, 8704
    s_add_u32 s48, s48, 23616
    s_lshl_b32 s49, s29, 6
    s_add_u32 s49, s49, s48
    v_add_u32 v97, s49, v96
    s_xor_b32 s49, s29, 2
    s_lshl_b32 s49, s49, 6
    s_add_u32 s49, s49, s48
    v_add_u32 v98, s49, v96
    s_waitcnt vmcnt(0) lgkmcnt(0)
    s_add_u32 s3, s3, 8
    s_mov_b64 exec, 1
    v_mov_b32 v126, 23524
    v_mov_b32 v127, 1
    ds_add_u32 v126, v127
    s_mov_b32 s70, 0x4000000
sw_h4:
    ds_read_b32 v127, v126
    s_sub_u32 s70, s70, 1
    s_cbranch_scc1 sw_out_h4
    s_waitcnt lgkmcnt(0)
    v_cmp_gt_u32 vcc, s3, v127
    s_cbranch_vccz sw_out_h4
    s_sleep 1
    s_branch sw_h4
sw_out_h4:
    s_waitcnt lgkmcnt(0)
    s_mov_b64 exec, -1
    ds_read_b128 v[64:67], v97 offset:0
    ds_read_b128 v[80:83], v97 offset:4352
    ds_read_b128 v[68:71], v97 offset:64
    ds_read_b128 v[84:87], v97 offset:4416
    ds_read_b128 v[72:75], v98 offset:0
    ds_read_b128 v[88:91], v98 offset:4352
    ds_read_b128 v[76:79], v98 offset:64
    ds_read_b128 v[92:95], v98 offset:4416
    s_waitcnt lgkmcnt(0)
    s_waitcnt lgkmcnt(0)
    s_add_u32 s3, s3, 8
    s_mov_b64 exec, 1
    v_mov_b32 v126, 23524
    v_mov_b32 v127, 1
    ds_add_u32 v126, v127
    s_mov_b32 s70, 0x4000000
sw_h5:
    ds_read_b32 v127, v126
    s_sub_u32 s70, s70, 1
    s_cbranch_scc1 sw_out_h5
    s_waitcnt lgkmcnt(0)
    v_cmp_gt_u32 vcc, s3, v127
    s_cbranch_vccz sw_out_h5
    s_sleep 1
    s_branch sw_h5
sw_out_h5:
    s_waitcnt lgkmcnt(0)
    s_mov_b64 exec, -1
    s_add_u32 s48, s29, 0
    s_and_b32 s48, s48, 3
    s_lshl_b32 s49, s48, 14
    s_add_u32 s49, s49, s30
    s_add_u32 s49, s49, 65536
    s_add_u32 m0, s31, 23616
    s_nop 0
    buffer_load_dwordx4 v117, s[32:35], s49 offen lds
    s_add_u32 m0, s31, 24704
    s_add_u32 s49, s49, 1024
    buffer_load_dwordx4 v117, s[32:35], s49 offen lds
    s_add_u32 s48, s29, 1
    s_and_b32 s48, s48, 3
    s_lshl_b32 s49, s48, 14
    s_add_u32 s49, s49, s30
    s_add_u32 s49, s49, 65536
    s_add_u32 m0, s31, 41024
    s_nop 0
    buffer_load_dwordx4 v117, s[32:35], s49 offen lds
    s_add_u32 m0, s31, 42112
    s_add_u32 s49, s49, 1024
    buffer_load_dwordx4 v117, s[32:35], s49 offen lds
    s_add_u32 s48, s29, 2
    s_and_b32 s48, s48, 3
    s_lshl_b32 s49, s48, 14
    s_add_u32 s49, s49, s30
    s_add_u32 s49, s49, 65536
    s_add_u32 m0, s31, 58432
    s_nop 0
    buffer_load_dwordx4 v117, s[32:35], s49 offen lds
    s_add_u32 m0, s31, 59520
    s_add_u32 s49, s49, 1024
    buffer_load_dwordx4 v117, s[32:35], s49 offen lds
    s_add_u32 s48, s29, 3
    s_and_b32 s48, s48, 3
    s_lshl_b32 s49, s48, 14
    s_add_u32 s49, s49, s30
    s_add_u32 s49, s49, 65536
    s_add_u32 m0, s31, 75840
    s_nop 0
    buffer_load_dwordx4 v117, s[32:35], s49 offen lds
    s_add_u32 m0, s31, 76928
    s_add_u32 s49, s49, 1024
    buffer_load_dwordx4 v117, s[32:35], s49 offen lds
    s_waitcnt vmcnt(0) lgkmcnt(0)
    s_add_u32 s3, s3, 8
    s_mov_b64 exec, 1
    v_mov_b32 v126, 23524
    v_mov_b32 v127, 1
    ds_add_u32 v126, v127
    s_mov_b32 s70, 0x4000000
sw_h6:
    ds_read_b32 v127, v126
    s_sub_u32 s70, s70, 1
    s_cbranch_scc1 sw_out_h6
    s_waitcnt lgkmcnt(0)
    v_cmp_gt_u32 vcc, s3, v127
    s_cbranch_vccz sw_out_h6
    s_sleep 1
    s_branch sw_h6
sw_out_h6:
    s_waitcnt lgkmcnt(0)
    s_mov_b64 exec, -1
    s_branch b_part
joined:
    s_waitcnt vmcnt(0) lgkmcnt(0)
    s_setprio 3
    s_barrier
    s_cmp_lg_u32 s25, 15
    s_cbranch_scc1 no_pub_2
    s_cmp_lg_u32 s26, 0
    s_cbranch_scc1 no_pub_2
    s_and_b32 s48, s2, 3
    s_lshl_b32 s49, s48, 6
    s_mov_b64 exec, 1
    v_mov_b32 v127, 1
    v_mov_b32 v126, s49
    buffer_atomic_add v127, v126, s[72:75], 0 offen offset:8 sc0 sc1
    s_mov_b64 exec, -1
    s_lshl_b32 s48, s48, 2
    s_add_u32 s48, s48, 0x3c0020
    s_waitcnt vmcnt(0)
    v_readfirstlane_b32 s49, v127
    v_lshlrev_b32 v126, 7, v113
    v_mov_b32 v127, 1
    s_and_b32 s49, s49, 63
    s_cmp_lg_u32 s49, 63
    s_cbranch_scc1 pub_done_2
    s_mov_b32 exec_hi, 0
    buffer_atomic_add v127, v126, s[12:15], s48 offen sc1
    s_mov_b64 exec, -1
pub_done_2:
no_pub_2:
    ds_read_b32 v122, v118 offset:4
    v_lshlrev_b32 v120, 2, v113
    ds_read_b32 v108, v120 offset:23392
    v_mov_b32 v96, 0
    v_mov_b32 v97, 0
    v_mov_b32 v98, 0
    v_mov_b32 v99, 0
    v_mov_b32 v100, 0
    v_mov_b32 v101, 0
    v_mov_b32 v102, 0
    v_mov_b32 v103, 0
    s_waitcnt lgkmcnt(0)
    v_readfirstlane_b32 s28, v122
    s_mov_b32 s63, s25
    s_mov_b32 s36, s25
    s_mov_b64 s[60:61], 0
    s_mov_b32 s62, 0
    s_cmp_ge_u32 s63, 50
    s_cbranch_scc1 hp_end_init
    s_cmp_ge_u32 s63, 25
    s_cselect_b32 s49, 1, 0
    s_cselect_b32 s48, 25, 0
    s_sub_u32 s48, s63, s48
    v_readlane_b32 s50, v108, s48
    s_lshl_b32 s33, s49, 8
    s_mov_b32 s31, 192
    s_and_b32 s48, s50, 0xffff
    s_add_u32 s48, s48, 128
    s_lshr_b32 s30, s50, 16
    s_branch hp_out_init
hp_end_init:
    s_mov_b32 s48, 18304
    s_mov_b32 s31, 0
    s_mov_b32 s30, 0x7fffffff
hp_out_init:
    v_add_u32 v106, s48, v105
    ds_read2_b64 v[32:35], v106 offset0:0 offset1:4
    s_mov_b32 s34, s33
    s_sub_u32 s30, s30, 1
    s_cmp_lg_u32 s30, 0
    s_cbranch_scc1 prime_0
    s_mov_b64 exec, 1
    v_mov_b32 v120, 1
    ds_add_rtn_u32 v120, v118, v120 offset:12
    s_mov_b64 exec, -1
    s_waitcnt lgkmcnt(0)
    v_readfirstlane_b32 s63, v120
    s_mov_b32 s48, s63
    s_mov_b32 s49, 0
    s_lshl_b64 s[48:49], s[48:49], s62
    s_or_b64 s[60:61], s[60:61], s[48:49]
    s_add_u32 s62, s62, 8
    s_cmp_ge_u32 s63, 50
    s_cbranch_scc1 hp_end_prime0
    s_cmp_ge_u32 s63, 25
    s_cselect_b32 s49, 1, 0
    s_cselect_b32 s48, 25, 0
    s_sub_u32 s48, s63, s48
    v_readlane_b32 s50, v108, s48
    s_lshl_b32 s33, s49, 8
    s_andn2_b32 s49, s49, s71
    s_cbranch_scc0 hp_ok_prime0
    v_mov_b32 v126, 0
    ds_read_b32 v127, v126 offset:23584
    s_waitcnt lgkmcnt(0)
    v_readfirstlane_b32 s71, v127
    s_cmp_lg_u32 s71, 0
    s_cbranch_scc1 as_done_prime0
    v_lshlrev_b32 v126, 2, v113
    s_lshr_b32 s48, s2, 3
    s_lshl_b32 s48, s48, 7
    s_add_u32 s48, s48, 0x3c0020
    s_mov_b32 s49, 0x40000
    s_mov_b64 exec, 15
    ds_read_b32 v119, v126 offset:23568
aw_2prime0:
    v_mov_b32 v127, 0
    buffer_atomic_add v127, v126, s[12:15], s48 offen sc0 sc1
    s_sub_u32 s49, s49, 1
    s_cbranch_scc1 aw_done_2prime0
    s_waitcnt vmcnt(0) lgkmcnt(0)
    v_cmp_eq_u32 vcc, v119, v127
    s_cbranch_vccz aw_done_2prime0
    s_sleep 4
    s_branch aw_2prime0
aw_done_2prime0:
    s_waitcnt vmcnt(0) lgkmcnt(0)
    s_mov_b64 exec, -1
    s_mov_b32 s71, 1
    v_mov_b32 v126, 0
    v_mov_b32 v127, 1
    ds_write_b32 v126, v127 offset:23584
as_done_prime0:
hp_ok_prime0:
    s_mov_b32 s31, 192
    s_and_b32 s48, s50, 0xffff
    s_add_u32 s48, s48, 64
    s_lshr_b32 s30, s50, 16
    s_branch hp_out_prime0
hp_end_prime0:
    s_mov_b32 s48, 18304
    s_mov_b32 s31, 0
    s_mov_b32 s30, 0x7fffffff
hp_out_prime0:
    v_add_u32 v106, s48, v105
prime_0:
    s_waitcnt lgkmcnt(0)
    buffer_load_dwordx4 v[0:3], v32, s[76:79], s34 offen
    buffer_load_dwordx4 v[4:7], v34, s[76:79], s34 offen
    ds_read2_b64 v[36:39], v106 offset0:8 offset1:12
    s_mov_b32 s34, s33
    s_sub_u32 s30, s30, 1
    s_cmp_lg_u32 s30, 0
    s_cbranch_scc1 prime_1
    s_mov_b64 exec, 1
    v_mov_b32 v120, 1
    ds_add_rtn_u32 v120, v118, v120 offset:12
    s_mov_b64 exec, -1
    s_waitcnt lgkmcnt(0)
    v_readfirstlane_b32 s63, v120
    s_mov_b32 s48, s63
    s_mov_b32 s49, 0
    s_lshl_b64 s[48:49], s[48:49], s62
    s_or_b64 s[60:61], s[60:61], s[48:49]
    s_add_u32 s62, s62, 8
    s_cmp_ge_u32 s63, 50
    s_cbranch_scc1 hp_end_prime1
    s_cmp_ge_u32 s63, 25
    s_cselect_b32 s49, 1, 0
    s_cselect_b32 s48, 25, 0
    s_sub_u32 s48, s63, s48
    v_readlane_b32 s50, v108, s48
    s_lshl_b32 s33, s49, 8
    s_andn2_b32 s49, s49, s71
    s_cbranch_scc0 hp_ok_prime1
    v_mov_b32 v126, 0
    ds_read_b32 v127, v126 offset:23584
    s_waitcnt lgkmcnt(0)
    v_readfirstlane_b32 s71, v127
    s_cmp_lg_u32 s71, 0
    s_cbranch_scc1 as_done_prime1
    v_lshlrev_b32 v126, 2, v113
    s_lshr_b32 s48, s2, 3
    s_lshl_b32 s48, s48, 7
    s_add_u32 s48, s48, 0x3c0020
    s_mov_b32 s49, 0x40000
    s_mov_b64 exec, 15
    ds_read_b32 v119, v126 offset:23568
aw_2prime1:
    v_mov_b32 v127, 0
    buffer_atomic_add v127, v126, s[12:15], s48 offen sc0 sc1
    s_sub_u32 s49, s49, 1
    s_cbranch_scc1 aw_done_2prime1
    s_waitcnt vmcnt(0) lgkmcnt(0)
    v_cmp_eq_u32 vcc, v119, v127
    s_cbranch_vccz aw_done_2prime1
    s_sleep 4
    s_branch aw_2prime1
aw_done_2prime1:
    s_waitcnt vmcnt(0) lgkmcnt(0)
    s_mov_b64 exec, -1
    s_mov_b32 s71, 1
    v_mov_b32 v126, 0
    v_mov_b32 v127, 1
    ds_write_b32 v126, v127 offset:23584
as_done_prime1:
hp_ok_prime1:
    s_mov_b32 s31, 192
    s_and_b32 s48, s50, 0xffff
    s_add_u32 s48, s48, 0
    s_lshr_b32 s30, s50, 16
    s_branch hp_out_prime1
hp_end_prime1:
    s_mov_b32 s48, 18304
    s_mov_b32 s31, 0
    s_mov_b32 s30, 0x7fffffff
hp_out_prime1:
    v_add_u32 v106, s48, v105
prime_1:
    s_waitcnt lgkmcnt(0)
    buffer_load_dwordx4 v[8:11], v36, s[76:79], s34 offen
    buffer_load_dwordx4 v[12:15], v38, s[76:79], s34 offen
    ds_read2_b64 v[40:43], v106 offset0:16 offset1:20
    v_add_u32 v106, s31, v106
    s_mov_b32 s34, s33
    s_sub_u32 s30, s30, 1
    s_cmp_lg_u32 s30, 0
    s_cbranch_scc1 prime_2
    s_mov_b64 exec, 1
    v_mov_b32 v120, 1
    ds_add_rtn_u32 v120, v118, v120 offset:12
    s_mov_b64 exec, -1
    s_waitcnt lgkmcnt(0)
    v_readfirstlane_b32 s63, v120
    s_mov_b32 s48, s63
    s_mov_b32 s49, 0
    s_lshl_b64 s[48:49], s[48:49], s62
    s_or_b64 s[60:61], s[60:61], s[48:49]
    s_add_u32 s62, s62, 8
    s_cmp_ge_u32 s63, 50
    s_cbranch_scc1 hp_end_prime2
    s_cmp_ge_u32 s63, 25
    s_cselect_b32 s49, 1, 0
    s_cselect_b32 s48, 25, 0
    s_sub_u32 s48, s63, s48
    v_readlane_b32 s50, v108, s48
    s_lshl_b32 s33, s49, 8
    s_andn2_b32 s49, s49, s71
    s_cbranch_scc0 hp_ok_prime2
    v_mov_b32 v126, 0
    ds_read_b32 v127, v126 offset:23584
    s_waitcnt lgkmcnt(0)
    v_readfirstlane_b32 s71, v127
    s_cmp_lg_u32 s71, 0
    s_cbranch_scc1 as_done_prime2
    v_lshlrev_b32 v126, 2, v113
    s_lshr_b32 s48, s2, 3
    s_lshl_b32 s48, s48, 7
    s_add_u32 s48, s48, 0x3c0020
    s_mov_b32 s49, 0x40000
    s_mov_b64 exec, 15
    ds_read_b32 v119, v126 offset:23568
aw_2prime2:
    v_mov_b32 v127, 0
    buffer_atomic_add v127, v126, s[12:15], s48 offen sc0 sc1
    s_sub_u32 s49, s49, 1
    s_cbranch_scc1 aw_done_2prime2
    s_waitcnt vmcnt(0) lgkmcnt(0)
    v_cmp_eq_u32 vcc, v119, v127
    s_cbranch_vccz aw_done_2prime2
    s_sleep 4
    s_branch aw_2prime2
aw_done_2prime2:
    s_waitcnt vmcnt(0) lgkmcnt(0)
    s_mov_b64 exec, -1
    s_mov_b32 s71, 1
    v_mov_b32 v126, 0
    v_mov_b32 v127, 1
    ds_write_b32 v126, v127 offset:23584
as_done_prime2:
hp_ok_prime2:
    s_mov_b32 s31, 192
    s_and_b32 s48, s50, 0xffff
    s_add_u32 s48, s48, 128
    s_lshr_b32 s30, s50, 16
    s_branch hp_out_prime2
hp_end_prime2:
    s_mov_b32 s48, 18304
    s_mov_b32 s31, 0
    s_mov_b32 s30, 0x7fffffff
hp_out_prime2:
    v_add_u32 v106, s48, v105
prime_2:
    s_cmp_ge_u32 s36, 25
    s_cselect_b32 s37, 1, 0
    s_cselect_b32 s48, 25, 0
    s_sub_u32 s48, s36, s48
    s_lshl_b32 s49, s48, 4
    v_add_u32 v120, s49, v116
    ds_read_b32 v109, v120
    v_readlane_b32 s50, v108, s48
    s_lshl_b32 s49, s37, 9
    v_add_u32 v120, s49, v115
    s_lshr_b32 s35, s50, 16
    ds_read_b128 v[48:51], v120 offset:1024
    ds_read_b128 v[52:55], v120 offset:1040
    ds_read_b128 v[56:59], v120
    ds_read_b128 v[60:63], v120 offset:16
    s_lshl_b32 s49, s37, 8
    s_add_u32 s49, s49, 23600
    v_add_u32 v107, s49, v104
    s_mov_b32 s49, 528
    s_setprio 3
    s_cmp_lt_u32 s36, 13
    s_cbranch_scc1 prio_init
    s_setprio 2
    s_cmp_lt_u32 s36, 25
    s_cbranch_scc1 prio_init
    s_setprio 1
    s_cmp_lt_u32 s36, 38
    s_cbranch_scc1 prio_init
    s_setprio 0
prio_init:
    s_waitcnt lgkmcnt(4)
    v_mad_u32_u24 v107, v109, s49, v107
    ds_read_b128 v[72:75], v107
    v_mov_b64 v[64:65], 0
    v_mov_b64 v[66:67], 0
    v_mov_b64 v[68:69], 0
    v_mov_b64 v[70:71], 0
    s_waitcnt lgkmcnt(0)
    v_dot2_f32_bf16 v48, v72, s38, v48
    v_dot2_f32_bf16 v49, v72, s32, v49
    v_dot2_f32_bf16 v50, v73, s38, v50
    v_dot2_f32_bf16 v51, v73, s32, v51
    v_dot2_f32_bf16 v52, v74, s38, v52
    v_dot2_f32_bf16 v53, v74, s32, v53
    v_dot2_f32_bf16 v54, v75, s38, v54
    v_dot2_f32_bf16 v55, v75, s32, v55
loop_top:
    buffer_load_dwordx4 v[16:19], v40, s[76:79], s34 offen
    buffer_load_dwordx4 v[20:23], v42, s[76:79], s34 offen
    v_pk_fma_f32 v[72:73], v[32:33], v[56:57], v[48:49] op_sel:[1,0,0] op_sel_hi:[1,1,1]
    v_pk_fma_f32 v[74:75], v[32:33], v[58:59], v[50:51] op_sel:[1,0,0] op_sel_hi:[1,1,1]
    v_pk_fma_f32 v[76:77], v[32:33], v[60:61], v[52:53] op_sel:[1,0,0] op_sel_hi:[1,1,1]
    v_pk_fma_f32 v[78:79], v[32:33], v[62:63], v[54:55] op_sel:[1,0,0] op_sel_hi:[1,1,1]
    v_pk_fma_f32 v[80:81], v[34:35], v[56:57], v[48:49] op_sel:[1,0,0] op_sel_hi:[1,1,1]
    v_pk_fma_f32 v[82:83], v[34:35], v[58:59], v[50:51] op_sel:[1,0,0] op_sel_hi:[1,1,1]
    v_pk_fma_f32 v[84:85], v[34:35], v[60:61], v[52:53] op_sel:[1,0,0] op_sel_hi:[1,1,1]
    v_pk_fma_f32 v[86:87], v[34:35], v[62:63], v[54:55] op_sel:[1,0,0] op_sel_hi:[1,1,1]
    ds_read2_b64 v[32:35], v106 offset0:0 offset1:4
    s_mov_b32 s34, s33
    s_sub_u32 s30, s30, 1
    s_cmp_eq_u32 s30, 0
    s_cbranch_scc1 hookP_0
backP_0:
    s_waitcnt vmcnt(4)
    v_pk_add_f32 v[76:77], v[0:1], v[76:77]
    v_pk_add_f32 v[78:79], v[2:3], v[78:79]
    v_pk_add_f32 v[84:85], v[4:5], v[84:85]
    v_pk_add_f32 v[86:87], v[6:7], v[86:87]
    v_mad_u32_u16 v76, v76, 2, s39 op_sel:[1,0,0,0]
    ds_read_u16_d16_hi v96, v76
    v_mad_u32_u16 v77, v77, 2, s39 op_sel:[1,0,0,0]
    ds_read_u16_d16_hi v97, v77
    v_mad_u32_u16 v78, v78, 2, s39 op_sel:[1,0,0,0]
    ds_read_u16_d16_hi v98, v78
    v_mad_u32_u16 v79, v79, 2, s39 op_sel:[1,0,0,0]
    ds_read_u16_d16_hi v99, v79
    v_mad_u32_u16 v84, v84, 2, s39 op_sel:[1,0,0,0]
    ds_read_u16_d16_hi v100, v84
    v_mad_u32_u16 v85, v85, 2, s39 op_sel:[1,0,0,0]
    ds_read_u16_d16_hi v101, v85
    v_mad_u32_u16 v86, v86, 2, s39 op_sel:[1,0,0,0]
    ds_read_u16_d16_hi v102, v86
    v_mad_u32_u16 v87, v87, 2, s39 op_sel:[1,0,0,0]
    ds_read_u16_d16_hi v103, v87
    v_dot2_f32_bf16 v72, v0, s38, v72
    v_dot2_f32_bf16 v73, v1, s38, v73
    v_dot2_f32_bf16 v74, v2, s38, v74
    v_dot2_f32_bf16 v75, v3, s38, v75
    v_dot2_f32_bf16 v80, v4, s38, v80
    v_dot2_f32_bf16 v81, v5, s38, v81
    v_dot2_f32_bf16 v82, v6, s38, v82
    v_dot2_f32_bf16 v83, v7, s38, v83
    v_exp_f32 v88, -v72
    v_exp_f32 v89, -v73
    v_exp_f32 v92, -v80
    v_exp_f32 v93, -v81
    v_pk_fma_f32 v[88:89], v[88:89], s[40:41], s[40:41] clamp
    v_pk_fma_f32 v[92:93], v[92:93], s[40:41], s[40:41] clamp
    v_pk_mul_f32 v[80:81], v[80:81], v[88:89]
    v_pk_mul_f32 v[88:89], v[88:89], v[92:93]
    v_pk_fma_f32 v[72:73], v[72:73], v[92:93], v[80:81]
    v_rcp_f32 v88, v88
    v_rcp_f32 v89, v89
    v_exp_f32 v90, -v74
    v_exp_f32 v91, -v75
    v_pk_fma_f32 v[64:65], v[72:73], v[88:89], v[64:65]
    v_exp_f32 v94, -v82
    v_exp_f32 v95, -v83
    v_pk_fma_f32 v[90:91], v[90:91], s[40:41], s[40:41] clamp
    v_pk_fma_f32 v[94:95], v[94:95], s[40:41], s[40:41] clamp
    v_pk_mul_f32 v[82:83], v[82:83], v[90:91]
    v_pk_mul_f32 v[90:91], v[90:91], v[94:95]
    v_pk_fma_f32 v[74:75], v[74:75], v[94:95], v[82:83]
    v_rcp_f32 v90, v90
    v_rcp_f32 v91, v91
    s_waitcnt lgkmcnt(6)
    v_pk_add_f32 v[68:69], v[68:69], v[96:97]
    v_pk_fma_f32 v[66:67], v[74:75], v[90:91], v[66:67]
    s_waitcnt lgkmcnt(4)
    v_pk_add_f32 v[70:71], v[70:71], v[98:99]
    s_waitcnt lgkmcnt(2)
    v_pk_add_f32 v[68:69], v[68:69], v[100:101]
    s_waitcnt lgkmcnt(0)
    v_pk_add_f32 v[70:71], v[70:71], v[102:103]
    s_sub_u32 s35, s35, 1
    s_cmp_eq_u32 s35, 0
    s_cbranch_scc1 hookC_0
backC_0:
    buffer_load_dwordx4 v[0:3], v32, s[76:79], s34 offen
    buffer_load_dwordx4 v[4:7], v34, s[76:79], s34 offen
    v_pk_fma_f32 v[72:73], v[36:37], v[56:57], v[48:49] op_sel:[1,0,0] op_sel_hi:[1,1,1]
    v_pk_fma_f32 v[74:75], v[36:37], v[58:59], v[50:51] op_sel:[1,0,0] op_sel_hi:[1,1,1]
    v_pk_fma_f32 v[76:77], v[36:37], v[60:61], v[52:53] op_sel:[1,0,0] op_sel_hi:[1,1,1]
    v_pk_fma_f32 v[78:79], v[36:37], v[62:63], v[54:55] op_sel:[1,0,0] op_sel_hi:[1,1,1]
    v_pk_fma_f32 v[80:81], v[38:39], v[56:57], v[48:49] op_sel:[1,0,0] op_sel_hi:[1,1,1]
    v_pk_fma_f32 v[82:83], v[38:39], v[58:59], v[50:51] op_sel:[1,0,0] op_sel_hi:[1,1,1]
    v_pk_fma_f32 v[84:85], v[38:39], v[60:61], v[52:53] op_sel:[1,0,0] op_sel_hi:[1,1,1]
    v_pk_fma_f32 v[86:87], v[38:39], v[62:63], v[54:55] op_sel:[1,0,0] op_sel_hi:[1,1,1]
    ds_read2_b64 v[36:39], v106 offset0:8 offset1:12
    s_mov_b32 s34, s33
    s_sub_u32 s30, s30, 1
    s_cmp_eq_u32 s30, 0
    s_cbranch_scc1 hookP_1
backP_1:
    s_waitcnt vmcnt(4)
    v_pk_add_f32 v[76:77], v[8:9], v[76:77]
    v_pk_add_f32 v[78:79], v[10:11], v[78:79]
    v_pk_add_f32 v[84:85], v[12:13], v[84:85]
    v_pk_add_f32 v[86:87], v[14:15], v[86:87]
    v_mad_u32_u16 v76, v76, 2, s39 op_sel:[1,0,0,0]
    ds_read_u16_d16_hi v96, v76
    v_mad_u32_u16 v77, v77, 2, s39 op_sel:[1,0,0,0]
    ds_read_u16_d16_hi v97, v77
    v_mad_u32_u16 v78, v78, 2, s39 op_sel:[1,0,0,0]
    ds_read_u16_d16_hi v98, v78
    v_mad_u32_u16 v79, v79, 2, s39 op_sel:[1,0,0,0]
    ds_read_u16_d16_hi v99, v79
    v_mad_u32_u16 v84, v84, 2, s39 op_sel:[1,0,0,0]
    ds_read_u16_d16_hi v100, v84
    v_mad_u32_u16 v85, v85, 2, s39 op_sel:[1,0,0,0]
    ds_read_u16_d16_hi v101, v85
    v_mad_u32_u16 v86, v86, 2, s39 op_sel:[1,0,0,0]
    ds_read_u16_d16_hi v102, v86
    v_mad_u32_u16 v87, v87, 2, s39 op_sel:[1,0,0,0]
    ds_read_u16_d16_hi v103, v87
    v_dot2_f32_bf16 v72, v8, s38, v72
    v_dot2_f32_bf16 v73, v9, s38, v73
    v_dot2_f32_bf16 v74, v10, s38, v74
    v_dot2_f32_bf16 v75, v11, s38, v75
    v_dot2_f32_bf16 v80, v12, s38, v80
    v_dot2_f32_bf16 v81, v13, s38, v81
    v_dot2_f32_bf16 v82, v14, s38, v82
    v_dot2_f32_bf16 v83, v15, s38, v83
    v_exp_f32 v88, -v72
    v_exp_f32 v89, -v73
    v_exp_f32 v92, -v80
    v_exp_f32 v93, -v81
    v_pk_fma_f32 v[88:89], v[88:89], s[40:41], s[40:41] clamp
    v_pk_fma_f32 v[92:93], v[92:93], s[40:41], s[40:41] clamp
    v_pk_mul_f32 v[80:81], v[80:81], v[88:89]
    v_pk_mul_f32 v[88:89], v[88:89], v[92:93]
    v_pk_fma_f32 v[72:73], v[72:73], v[92:93], v[80:81]
    v_rcp_f32 v88, v88
    v_rcp_f32 v89, v89
    v_exp_f32 v90, -v74
    v_exp_f32 v91, -v75
    v_pk_fma_f32 v[64:65], v[72:73], v[88:89], v[64:65]
    v_exp_f32 v94, -v82
    v_exp_f32 v95, -v83
    v_pk_fma_f32 v[90:91], v[90:91], s[40:41], s[40:41] clamp
    v_pk_fma_f32 v[94:95], v[94:95], s[40:41], s[40:41] clamp
    v_pk_mul_f32 v[82:83], v[82:83], v[90:91]
    v_pk_mul_f32 v[90:91], v[90:91], v[94:95]
    v_pk_fma_f32 v[74:75], v[74:75], v[94:95], v[82:83]
    v_rcp_f32 v90, v90
    v_rcp_f32 v91, v91
    s_waitcnt lgkmcnt(6)
    v_pk_add_f32 v[68:69], v[68:69], v[96:97]
    v_pk_fma_f32 v[66:67], v[74:75], v[90:91], v[66:67]
    s_waitcnt lgkmcnt(4)
    v_pk_add_f32 v[70:71], v[70:71], v[98:99]
    s_waitcnt lgkmcnt(2)
    v_pk_add_f32 v[68:69], v[68:69], v[100:101]
    s_waitcnt lgkmcnt(0)
    v_pk_add_f32 v[70:71], v[70:71], v[102:103]
    s_sub_u32 s35, s35, 1
    s_cmp_eq_u32 s35, 0
    s_cbranch_scc1 hookC_1
backC_1:
    buffer_load_dwordx4 v[8:11], v36, s[76:79], s34 offen
    buffer_load_dwordx4 v[12:15], v38, s[76:79], s34 offen
    v_pk_fma_f32 v[72:73], v[40:41], v[56:57], v[48:49] op_sel:[1,0,0] op_sel_hi:[1,1,1]
    v_pk_fma_f32 v[74:75], v[40:41], v[58:59], v[50:51] op_sel:[1,0,0] op_sel_hi:[1,1,1]
    v_pk_fma_f32 v[76:77], v[40:41], v[60:61], v[52:53] op_sel:[1,0,0] op_sel_hi:[1,1,1]
    v_pk_fma_f32 v[78:79], v[40:41], v[62:63], v[54:55] op_sel:[1,0,0] op_sel_hi:[1,1,1]
    v_pk_fma_f32 v[80:81], v[42:43], v[56:57], v[48:49] op_sel:[1,0,0] op_sel_hi:[1,1,1]
    v_pk_fma_f32 v[82:83], v[42:43], v[58:59], v[50:51] op_sel:[1,0,0] op_sel_hi:[1,1,1]
    v_pk_fma_f32 v[84:85], v[42:43], v[60:61], v[52:53] op_sel:[1,0,0] op_sel_hi:[1,1,1]
    v_pk_fma_f32 v[86:87], v[42:43], v[62:63], v[54:55] op_sel:[1,0,0] op_sel_hi:[1,1,1]
    ds_read2_b64 v[40:43], v106 offset0:16 offset1:20
    v_add_u32 v106, s31, v106
    s_mov_b32 s34, s33
    s_sub_u32 s30, s30, 1
    s_cmp_eq_u32 s30, 0
    s_cbranch_scc1 hookP_2
backP_2:
    s_waitcnt vmcnt(4)
    v_pk_add_f32 v[76:77], v[16:17], v[76:77]
    v_pk_add_f32 v[78:79], v[18:19], v[78:79]
    v_pk_add_f32 v[84:85], v[20:21], v[84:85]
    v_pk_add_f32 v[86:87], v[22:23], v[86:87]
    v_mad_u32_u16 v76, v76, 2, s39 op_sel:[1,0,0,0]
    ds_read_u16_d16_hi v96, v76
    v_mad_u32_u16 v77, v77, 2, s39 op_sel:[1,0,0,0]
    ds_read_u16_d16_hi v97, v77
    v_mad_u32_u16 v78, v78, 2, s39 op_sel:[1,0,0,0]
    ds_read_u16_d16_hi v98, v78
    v_mad_u32_u16 v79, v79, 2, s39 op_sel:[1,0,0,0]
    ds_read_u16_d16_hi v99, v79
    v_mad_u32_u16 v84, v84, 2, s39 op_sel:[1,0,0,0]
    ds_read_u16_d16_hi v100, v84
    v_mad_u32_u16 v85, v85, 2, s39 op_sel:[1,0,0,0]
    ds_read_u16_d16_hi v101, v85
    v_mad_u32_u16 v86, v86, 2, s39 op_sel:[1,0,0,0]
    ds_read_u16_d16_hi v102, v86
    v_mad_u32_u16 v87, v87, 2, s39 op_sel:[1,0,0,0]
    ds_read_u16_d16_hi v103, v87
    v_dot2_f32_bf16 v72, v16, s38, v72
    v_dot2_f32_bf16 v73, v17, s38, v73
    v_dot2_f32_bf16 v74, v18, s38, v74
    v_dot2_f32_bf16 v75, v19, s38, v75
    v_dot2_f32_bf16 v80, v20, s38, v80
    v_dot2_f32_bf16 v81, v21, s38, v81
    v_dot2_f32_bf16 v82, v22, s38, v82
    v_dot2_f32_bf16 v83, v23, s38, v83
    v_exp_f32 v88, -v72
    v_exp_f32 v89, -v73
    v_exp_f32 v92, -v80
    v_exp_f32 v93, -v81
    v_pk_fma_f32 v[88:89], v[88:89], s[40:41], s[40:41] clamp
    v_pk_fma_f32 v[92:93], v[92:93], s[40:41], s[40:41] clamp
    v_pk_mul_f32 v[80:81], v[80:81], v[88:89]
    v_pk_mul_f32 v[88:89], v[88:89], v[92:93]
    v_pk_fma_f32 v[72:73], v[72:73], v[92:93], v[80:81]
    v_rcp_f32 v88, v88
    v_rcp_f32 v89, v89
    v_exp_f32 v90, -v74
    v_exp_f32 v91, -v75
    v_pk_fma_f32 v[64:65], v[72:73], v[88:89], v[64:65]
    v_exp_f32 v94, -v82
    v_exp_f32 v95, -v83
    v_pk_fma_f32 v[90:91], v[90:91], s[40:41], s[40:41] clamp
    v_pk_fma_f32 v[94:95], v[94:95], s[40:41], s[40:41] clamp
    v_pk_mul_f32 v[82:83], v[82:83], v[90:91]
    v_pk_mul_f32 v[90:91], v[90:91], v[94:95]
    v_pk_fma_f32 v[74:75], v[74:75], v[94:95], v[82:83]
    v_rcp_f32 v90, v90
    v_rcp_f32 v91, v91
    s_waitcnt lgkmcnt(6)
    v_pk_add_f32 v[68:69], v[68:69], v[96:97]
    v_pk_fma_f32 v[66:67], v[74:75], v[90:91], v[66:67]
    s_waitcnt lgkmcnt(4)
    v_pk_add_f32 v[70:71], v[70:71], v[98:99]
    s_waitcnt lgkmcnt(2)
    v_pk_add_f32 v[68:69], v[68:69], v[100:101]
    s_waitcnt lgkmcnt(0)
    v_pk_add_f32 v[70:71], v[70:71], v[102:103]
    s_sub_u32 s35, s35, 1
    s_cmp_eq_u32 s35, 0
    s_cbranch_scc1 hookC_2
backC_2:
    s_branch loop_top
hookP_0:
    s_mov_b64 exec, 1
    v_mov_b32 v120, 1
    ds_add_rtn_u32 v120, v118, v120 offset:12
    s_mov_b64 exec, -1
    s_waitcnt lgkmcnt(0)
    v_readfirstlane_b32 s63, v120
    s_mov_b32 s48, s63
    s_mov_b32 s49, 0
    s_lshl_b64 s[48:49], s[48:49], s62
    s_or_b64 s[60:61], s[60:61], s[48:49]
    s_add_u32 s62, s62, 8
    s_cmp_ge_u32 s63, 50
    s_cbranch_scc1 hp_end_h0
    s_cmp_ge_u32 s63, 25
    s_cselect_b32 s49, 1, 0
    s_cselect_b32 s48, 25, 0
    s_sub_u32 s48, s63, s48
    v_readlane_b32 s50, v108, s48
    s_lshl_b32 s33, s49, 8
    s_andn2_b32 s49, s49, s71
    s_cbranch_scc0 hp_ok_h0
    v_mov_b32 v126, 0
    ds_read_b32 v127, v126 offset:23584
    s_waitcnt lgkmcnt(0)
    v_readfirstlane_b32 s71, v127
    s_cmp_lg_u32 s71, 0
    s_cbranch_scc1 as_done_h0
    v_lshlrev_b32 v126, 2, v113
    s_lshr_b32 s48, s2, 3
    s_lshl_b32 s48, s48, 7
    s_add_u32 s48, s48, 0x3c0020
    s_mov_b32 s49, 0x40000
    s_mov_b64 exec, 15
    ds_read_b32 v119, v126 offset:23568
aw_2h0:
    v_mov_b32 v127, 0
    buffer_atomic_add v127, v126, s[12:15], s48 offen sc0 sc1
    s_sub_u32 s49, s49, 1
    s_cbranch_scc1 aw_done_2h0
    s_waitcnt vmcnt(0) lgkmcnt(0)
    v_cmp_eq_u32 vcc, v119, v127
    s_cbranch_vccz aw_done_2h0
    s_sleep 4
    s_branch aw_2h0
aw_done_2h0:
    s_waitcnt vmcnt(0) lgkmcnt(0)
    s_mov_b64 exec, -1
    s_mov_b32 s71, 1
    v_mov_b32 v126, 0
    v_mov_b32 v127, 1
    ds_write_b32 v126, v127 offset:23584
as_done_h0:
hp_ok_h0:
    s_mov_b32 s31, 192
    s_and_b32 s48, s50, 0xffff
    s_add_u32 s48, s48, 64
    s_lshr_b32 s30, s50, 16
    s_branch hp_out_h0
hp_end_h0:
    s_mov_b32 s48, 18304
    s_mov_b32 s31, 0
    s_mov_b32 s30, 0x7fffffff
hp_out_h0:
    v_add_u32 v106, s48, v105
    s_branch backP_0
hookC_0:
    s_or_b32 s48, s26, s28
    s_cbranch_scc0 fl_plain_h0
    s_mul_i32 s48, s24, 102400
    s_lshl_b32 s49, s37, 9
    s_add_u32 s48, s48, s49
    s_add_u32 s48, s48, 0x2000000
    v_lshlrev_b32 v120, 10, v109
    v_lshl_add_u32 v120, v104, 1, v120
    s_cmp_eq_u32 s26, 0
    s_cbranch_scc1 fl_noload_h0
    buffer_load_dwordx4 v[72:75], v120, s[12:15], s48 offen sc0 sc1
    buffer_load_dwordx4 v[76:79], v120, s[12:15], s48 offen offset:16 sc0 sc1
    s_waitcnt vmcnt(0)
    v_add_f32 v64, v64, v72
    v_add_f32 v65, v65, v73
    v_add_f32 v66, v66, v74
    v_add_f32 v67, v67, v75
    v_add_f32 v68, v68, v76
    v_add_f32 v69, v69, v77
    v_add_f32 v70, v70, v78
    v_add_f32 v71, v71, v79
fl_noload_h0:
    buffer_store_dwordx4 v[64:67], v120, s[12:15], s48 offen sc0 sc1
    buffer_store_dwordx4 v[68:71], v120, s[12:15], s48 offen offset:16 sc0 sc1
    s_waitcnt vmcnt(0)
fl_plain_h0:
    v_pk_mul_f32 v[64:65], v[64:65], s[44:45]
    v_pk_mul_f32 v[66:67], v[66:67], s[44:45]
    v_pk_mul_f32 v[68:69], v[68:69], s[46:47]
    v_pk_mul_f32 v[70:71], v[70:71], s[46:47]
    v_cvt_pk_bf16_f32 v72, v64, v65
    v_cvt_pk_bf16_f32 v73, v66, v67
    v_cvt_pk_bf16_f32 v74, v68, v69
    v_cvt_pk_bf16_f32 v75, v70, v71
    ds_write_b128 v107, v[72:75]
    s_and_b32 s36, s60, 0xff
    s_lshr_b64 s[60:61], s[60:61], 8
    s_sub_u32 s62, s62, 8
    s_cmp_ge_u32 s36, 50
    s_cbranch_scc1 loop_exit
    s_cmp_ge_u32 s36, 25
    s_cselect_b32 s37, 1, 0
    s_cselect_b32 s48, 25, 0
    s_sub_u32 s48, s36, s48
    s_lshl_b32 s49, s48, 4
    v_add_u32 v120, s49, v116
    ds_read_b32 v109, v120
    v_readlane_b32 s50, v108, s48
    s_lshl_b32 s49, s37, 9
    v_add_u32 v120, s49, v115
    s_lshr_b32 s35, s50, 16
    ds_read_b128 v[48:51], v120 offset:1024
    ds_read_b128 v[52:55], v120 offset:1040
    ds_read_b128 v[56:59], v120
    ds_read_b128 v[60:63], v120 offset:16
    s_lshl_b32 s49, s37, 8
    s_add_u32 s49, s49, 23600
    v_add_u32 v107, s49, v104
    s_mov_b32 s49, 528
    s_setprio 3
    s_cmp_lt_u32 s36, 13
    s_cbranch_scc1 prio_h0
    s_setprio 2
    s_cmp_lt_u32 s36, 25
    s_cbranch_scc1 prio_h0
    s_setprio 1
    s_cmp_lt_u32 s36, 38
    s_cbranch_scc1 prio_h0
    s_setprio 0
prio_h0:
    s_waitcnt lgkmcnt(4)
    v_mad_u32_u24 v107, v109, s49, v107
    ds_read_b128 v[72:75], v107
    v_mov_b64 v[64:65], 0
    v_mov_b64 v[66:67], 0
    v_mov_b64 v[68:69], 0
    v_mov_b64 v[70:71], 0
    s_waitcnt lgkmcnt(0)
    v_dot2_f32_bf16 v48, v72, s38, v48
    v_dot2_f32_bf16 v49, v72, s32, v49
    v_dot2_f32_bf16 v50, v73, s38, v50
    v_dot2_f32_bf16 v51, v73, s32, v51
    v_dot2_f32_bf16 v52, v74, s38, v52
    v_dot2_f32_bf16 v53, v74, s32, v53
    v_dot2_f32_bf16 v54, v75, s38, v54
    v_dot2_f32_bf16 v55, v75, s32, v55
    s_branch backC_0
hookP_1:
    s_mov_b64 exec, 1
    v_mov_b32 v120, 1
    ds_add_rtn_u32 v120, v118, v120 offset:12
    s_mov_b64 exec, -1
    s_waitcnt lgkmcnt(0)
    v_readfirstlane_b32 s63, v120
    s_mov_b32 s48, s63
    s_mov_b32 s49, 0
    s_lshl_b64 s[48:49], s[48:49], s62
    s_or_b64 s[60:61], s[60:61], s[48:49]
    s_add_u32 s62, s62, 8
    s_cmp_ge_u32 s63, 50
    s_cbranch_scc1 hp_end_h1
    s_cmp_ge_u32 s63, 25
    s_cselect_b32 s49, 1, 0
    s_cselect_b32 s48, 25, 0
    s_sub_u32 s48, s63, s48
    v_readlane_b32 s50, v108, s48
    s_lshl_b32 s33, s49, 8
    s_andn2_b32 s49, s49, s71
    s_cbranch_scc0 hp_ok_h1
    v_mov_b32 v126, 0
    ds_read_b32 v127, v126 offset:23584
    s_waitcnt lgkmcnt(0)
    v_readfirstlane_b32 s71, v127
    s_cmp_lg_u32 s71, 0
    s_cbranch_scc1 as_done_h1
    v_lshlrev_b32 v126, 2, v113
    s_lshr_b32 s48, s2, 3
    s_lshl_b32 s48, s48, 7
    s_add_u32 s48, s48, 0x3c0020
    s_mov_b32 s49, 0x40000
    s_mov_b64 exec, 15
    ds_read_b32 v119, v126 offset:23568
aw_2h1:
    v_mov_b32 v127, 0
    buffer_atomic_add v127, v126, s[12:15], s48 offen sc0 sc1
    s_sub_u32 s49, s49, 1
    s_cbranch_scc1 aw_done_2h1
    s_waitcnt vmcnt(0) lgkmcnt(0)
    v_cmp_eq_u32 vcc, v119, v127
    s_cbranch_vccz aw_done_2h1
    s_sleep 4
    s_branch aw_2h1
aw_done_2h1:
    s_waitcnt vmcnt(0) lgkmcnt(0)
    s_mov_b64 exec, -1
    s_mov_b32 s71, 1
    v_mov_b32 v126, 0
    v_mov_b32 v127, 1
    ds_write_b32 v126, v127 offset:23584
as_done_h1:
hp_ok_h1:
    s_mov_b32 s31, 192
    s_and_b32 s48, s50, 0xffff
    s_add_u32 s48, s48, 0
    s_lshr_b32 s30, s50, 16
    s_branch hp_out_h1
hp_end_h1:
    s_mov_b32 s48, 18304
    s_mov_b32 s31, 0
    s_mov_b32 s30, 0x7fffffff
hp_out_h1:
    v_add_u32 v106, s48, v105
    s_branch backP_1
hookC_1:
    s_or_b32 s48, s26, s28
    s_cbranch_scc0 fl_plain_h1
    s_mul_i32 s48, s24, 102400
    s_lshl_b32 s49, s37, 9
    s_add_u32 s48, s48, s49
    s_add_u32 s48, s48, 0x2000000
    v_lshlrev_b32 v120, 10, v109
    v_lshl_add_u32 v120, v104, 1, v120
    s_cmp_eq_u32 s26, 0
    s_cbranch_scc1 fl_noload_h1
    buffer_load_dwordx4 v[72:75], v120, s[12:15], s48 offen sc0 sc1
    buffer_load_dwordx4 v[76:79], v120, s[12:15], s48 offen offset:16 sc0 sc1
    s_waitcnt vmcnt(0)
    v_add_f32 v64, v64, v72
    v_add_f32 v65, v65, v73
    v_add_f32 v66, v66, v74
    v_add_f32 v67, v67, v75
    v_add_f32 v68, v68, v76
    v_add_f32 v69, v69, v77
    v_add_f32 v70, v70, v78
    v_add_f32 v71, v71, v79
fl_noload_h1:
    buffer_store_dwordx4 v[64:67], v120, s[12:15], s48 offen sc0 sc1
    buffer_store_dwordx4 v[68:71], v120, s[12:15], s48 offen offset:16 sc0 sc1
    s_waitcnt vmcnt(0)
fl_plain_h1:
    v_pk_mul_f32 v[64:65], v[64:65], s[44:45]
    v_pk_mul_f32 v[66:67], v[66:67], s[44:45]
    v_pk_mul_f32 v[68:69], v[68:69], s[46:47]
    v_pk_mul_f32 v[70:71], v[70:71], s[46:47]
    v_cvt_pk_bf16_f32 v72, v64, v65
    v_cvt_pk_bf16_f32 v73, v66, v67
    v_cvt_pk_bf16_f32 v74, v68, v69
    v_cvt_pk_bf16_f32 v75, v70, v71
    ds_write_b128 v107, v[72:75]
    s_and_b32 s36, s60, 0xff
    s_lshr_b64 s[60:61], s[60:61], 8
    s_sub_u32 s62, s62, 8
    s_cmp_ge_u32 s36, 50
    s_cbranch_scc1 loop_exit
    s_cmp_ge_u32 s36, 25
    s_cselect_b32 s37, 1, 0
    s_cselect_b32 s48, 25, 0
    s_sub_u32 s48, s36, s48
    s_lshl_b32 s49, s48, 4
    v_add_u32 v120, s49, v116
    ds_read_b32 v109, v120
    v_readlane_b32 s50, v108, s48
    s_lshl_b32 s49, s37, 9
    v_add_u32 v120, s49, v115
    s_lshr_b32 s35, s50, 16
    ds_read_b128 v[48:51], v120 offset:1024
    ds_read_b128 v[52:55], v120 offset:1040
    ds_read_b128 v[56:59], v120
    ds_read_b128 v[60:63], v120 offset:16
    s_lshl_b32 s49, s37, 8
    s_add_u32 s49, s49, 23600
    v_add_u32 v107, s49, v104
    s_mov_b32 s49, 528
    s_setprio 3
    s_cmp_lt_u32 s36, 13
    s_cbranch_scc1 prio_h1
    s_setprio 2
    s_cmp_lt_u32 s36, 25
    s_cbranch_scc1 prio_h1
    s_setprio 1
    s_cmp_lt_u32 s36, 38
    s_cbranch_scc1 prio_h1
    s_setprio 0
prio_h1:
    s_waitcnt lgkmcnt(4)
    v_mad_u32_u24 v107, v109, s49, v107
    ds_read_b128 v[72:75], v107
    v_mov_b64 v[64:65], 0
    v_mov_b64 v[66:67], 0
    v_mov_b64 v[68:69], 0
    v_mov_b64 v[70:71], 0
    s_waitcnt lgkmcnt(0)
    v_dot2_f32_bf16 v48, v72, s38, v48
    v_dot2_f32_bf16 v49, v72, s32, v49
    v_dot2_f32_bf16 v50, v73, s38, v50
    v_dot2_f32_bf16 v51, v73, s32, v51
    v_dot2_f32_bf16 v52, v74, s38, v52
    v_dot2_f32_bf16 v53, v74, s32, v53
    v_dot2_f32_bf16 v54, v75, s38, v54
    v_dot2_f32_bf16 v55, v75, s32, v55
    s_branch backC_1
hookP_2:
    s_mov_b64 exec, 1
    v_mov_b32 v120, 1
    ds_add_rtn_u32 v120, v118, v120 offset:12
    s_mov_b64 exec, -1
    s_waitcnt lgkmcnt(0)
    v_readfirstlane_b32 s63, v120
    s_mov_b32 s48, s63
    s_mov_b32 s49, 0
    s_lshl_b64 s[48:49], s[48:49], s62
    s_or_b64 s[60:61], s[60:61], s[48:49]
    s_add_u32 s62, s62, 8
    s_cmp_ge_u32 s63, 50
    s_cbranch_scc1 hp_end_h2
    s_cmp_ge_u32 s63, 25
    s_cselect_b32 s49, 1, 0
    s_cselect_b32 s48, 25, 0
    s_sub_u32 s48, s63, s48
    v_readlane_b32 s50, v108, s48
    s_lshl_b32 s33, s49, 8
    s_andn2_b32 s49, s49, s71
    s_cbranch_scc0 hp_ok_h2
    v_mov_b32 v126, 0
    ds_read_b32 v127, v126 offset:23584
    s_waitcnt lgkmcnt(0)
    v_readfirstlane_b32 s71, v127
    s_cmp_lg_u32 s71, 0
    s_cbranch_scc1 as_done_h2
    v_lshlrev_b32 v126, 2, v113
    s_lshr_b32 s48, s2, 3
    s_lshl_b32 s48, s48, 7
    s_add_u32 s48, s48, 0x3c0020
    s_mov_b32 s49, 0x40000
    s_mov_b64 exec, 15
    ds_read_b32 v119, v126 offset:23568
aw_2h2:
    v_mov_b32 v127, 0
    buffer_atomic_add v127, v126, s[12:15], s48 offen sc0 sc1
    s_sub_u32 s49, s49, 1
    s_cbranch_scc1 aw_done_2h2
    s_waitcnt vmcnt(0) lgkmcnt(0)
    v_cmp_eq_u32 vcc, v119, v127
    s_cbranch_vccz aw_done_2h2
    s_sleep 4
    s_branch aw_2h2
aw_done_2h2:
    s_waitcnt vmcnt(0) lgkmcnt(0)
    s_mov_b64 exec, -1
    s_mov_b32 s71, 1
    v_mov_b32 v126, 0
    v_mov_b32 v127, 1
    ds_write_b32 v126, v127 offset:23584
as_done_h2:
hp_ok_h2:
    s_mov_b32 s31, 192
    s_and_b32 s48, s50, 0xffff
    s_add_u32 s48, s48, 128
    s_lshr_b32 s30, s50, 16
    s_branch hp_out_h2
hp_end_h2:
    s_mov_b32 s48, 18304
    s_mov_b32 s31, 0
    s_mov_b32 s30, 0x7fffffff
hp_out_h2:
    v_add_u32 v106, s48, v105
    s_branch backP_2
hookC_2:
    s_or_b32 s48, s26, s28
    s_cbranch_scc0 fl_plain_h2
    s_mul_i32 s48, s24, 102400
    s_lshl_b32 s49, s37, 9
    s_add_u32 s48, s48, s49
    s_add_u32 s48, s48, 0x2000000
    v_lshlrev_b32 v120, 10, v109
    v_lshl_add_u32 v120, v104, 1, v120
    s_cmp_eq_u32 s26, 0
    s_cbranch_scc1 fl_noload_h2
    buffer_load_dwordx4 v[72:75], v120, s[12:15], s48 offen sc0 sc1
    buffer_load_dwordx4 v[76:79], v120, s[12:15], s48 offen offset:16 sc0 sc1
    s_waitcnt vmcnt(0)
    v_add_f32 v64, v64, v72
    v_add_f32 v65, v65, v73
    v_add_f32 v66, v66, v74
    v_add_f32 v67, v67, v75
    v_add_f32 v68, v68, v76
    v_add_f32 v69, v69, v77
    v_add_f32 v70, v70, v78
    v_add_f32 v71, v71, v79
fl_noload_h2:
    buffer_store_dwordx4 v[64:67], v120, s[12:15], s48 offen sc0 sc1
    buffer_store_dwordx4 v[68:71], v120, s[12:15], s48 offen offset:16 sc0 sc1
    s_waitcnt vmcnt(0)
fl_plain_h2:
    v_pk_mul_f32 v[64:65], v[64:65], s[44:45]
    v_pk_mul_f32 v[66:67], v[66:67], s[44:45]
    v_pk_mul_f32 v[68:69], v[68:69], s[46:47]
    v_pk_mul_f32 v[70:71], v[70:71], s[46:47]
    v_cvt_pk_bf16_f32 v72, v64, v65
    v_cvt_pk_bf16_f32 v73, v66, v67
    v_cvt_pk_bf16_f32 v74, v68, v69
    v_cvt_pk_bf16_f32 v75, v70, v71
    ds_write_b128 v107, v[72:75]
    s_and_b32 s36, s60, 0xff
    s_lshr_b64 s[60:61], s[60:61], 8
    s_sub_u32 s62, s62, 8
    s_cmp_ge_u32 s36, 50
    s_cbranch_scc1 loop_exit
    s_cmp_ge_u32 s36, 25
    s_cselect_b32 s37, 1, 0
    s_cselect_b32 s48, 25, 0
    s_sub_u32 s48, s36, s48
    s_lshl_b32 s49, s48, 4
    v_add_u32 v120, s49, v116
    ds_read_b32 v109, v120
    v_readlane_b32 s50, v108, s48
    s_lshl_b32 s49, s37, 9
    v_add_u32 v120, s49, v115
    s_lshr_b32 s35, s50, 16
    ds_read_b128 v[48:51], v120 offset:1024
    ds_read_b128 v[52:55], v120 offset:1040
    ds_read_b128 v[56:59], v120
    ds_read_b128 v[60:63], v120 offset:16
    s_lshl_b32 s49, s37, 8
    s_add_u32 s49, s49, 23600
    v_add_u32 v107, s49, v104
    s_mov_b32 s49, 528
    s_setprio 3
    s_cmp_lt_u32 s36, 13
    s_cbranch_scc1 prio_h2
    s_setprio 2
    s_cmp_lt_u32 s36, 25
    s_cbranch_scc1 prio_h2
    s_setprio 1
    s_cmp_lt_u32 s36, 38
    s_cbranch_scc1 prio_h2
    s_setprio 0
prio_h2:
    s_waitcnt lgkmcnt(4)
    v_mad_u32_u24 v107, v109, s49, v107
    ds_read_b128 v[72:75], v107
    v_mov_b64 v[64:65], 0
    v_mov_b64 v[66:67], 0
    v_mov_b64 v[68:69], 0
    v_mov_b64 v[70:71], 0
    s_waitcnt lgkmcnt(0)
    v_dot2_f32_bf16 v48, v72, s38, v48
    v_dot2_f32_bf16 v49, v72, s32, v49
    v_dot2_f32_bf16 v50, v73, s38, v50
    v_dot2_f32_bf16 v51, v73, s32, v51
    v_dot2_f32_bf16 v52, v74, s38, v52
    v_dot2_f32_bf16 v53, v74, s32, v53
    v_dot2_f32_bf16 v54, v75, s38, v54
    v_dot2_f32_bf16 v55, v75, s32, v55
    s_branch backC_2
loop_exit:
    s_setprio 0
    s_cmp_eq_u32 s28, 0
    s_cbranch_scc1 last_round
    s_add_u32 s26, s26, 1
    s_branch next_round
last_round:
    s_cmp_lg_u32 s71, 0
    s_cbranch_scc1 w2_ok
    v_mov_b32 v126, 0
    ds_read_b32 v127, v126 offset:23584
    s_waitcnt lgkmcnt(0)
    v_readfirstlane_b32 s71, v127
    s_cmp_lg_u32 s71, 0
    s_cbranch_scc1 as_done_end
    v_lshlrev_b32 v126, 2, v113
    s_lshr_b32 s48, s2, 3
    s_lshl_b32 s48, s48, 7
    s_add_u32 s48, s48, 0x3c0020
    s_mov_b32 s49, 0x40000
    s_mov_b64 exec, 15
    ds_read_b32 v119, v126 offset:23568
aw_2end:
    v_mov_b32 v127, 0
    buffer_atomic_add v127, v126, s[12:15], s48 offen sc0 sc1
    s_sub_u32 s49, s49, 1
    s_cbranch_scc1 aw_done_2end
    s_waitcnt vmcnt(0) lgkmcnt(0)
    v_cmp_eq_u32 vcc, v119, v127
    s_cbranch_vccz aw_done_2end
    s_sleep 4
    s_branch aw_2end
aw_done_2end:
    s_waitcnt vmcnt(0) lgkmcnt(0)
    s_mov_b64 exec, -1
    s_mov_b32 s71, 1
    v_mov_b32 v126, 0
    v_mov_b32 v127, 1
    ds_write_b32 v126, v127 offset:23584
as_done_end:
w2_ok:
    s_and_b32 s48, s25, 3
    s_lshr_b32 s49, s25, 2
    s_lshl_b32 s50, s48, 14
    s_add_u32 s50, s50, 0x3a0000
    v_lshlrev_b32 v120, 4, v113
    s_waitcnt lgkmcnt(0)
    buffer_load_dwordx4 v[0:3], v120, s[12:15], s50 offen offset:0 sc1
    buffer_load_dwordx4 v[4:7], v120, s[12:15], s50 offen offset:1024 sc1
    buffer_load_dwordx4 v[8:11], v120, s[12:15], s50 offen offset:2048 sc1
    buffer_load_dwordx4 v[12:15], v120, s[12:15], s50 offen offset:3072 sc1
    s_add_u32 s50, s50, 4096
    buffer_load_dwordx4 v[16:19], v120, s[12:15], s50 offen offset:0 sc1
    buffer_load_dwordx4 v[20:23], v120, s[12:15], s50 offen offset:1024 sc1
    buffer_load_dwordx4 v[24:27], v120, s[12:15], s50 offen offset:2048 sc1
    buffer_load_dwordx4 v[28:31], v120, s[12:15], s50 offen offset:3072 sc1
    s_add_u32 s50, s50, 4096
    buffer_load_dwordx4 v[32:35], v120, s[12:15], s50 offen offset:0 sc1
    buffer_load_dwordx4 v[36:39], v120, s[12:15], s50 offen offset:1024 sc1
    buffer_load_dwordx4 v[40:43], v120, s[12:15], s50 offen offset:2048 sc1
    buffer_load_dwordx4 v[44:47], v120, s[12:15], s50 offen offset:3072 sc1
    s_add_u32 s50, s50, 4096
    buffer_load_dwordx4 v[48:51], v120, s[12:15], s50 offen offset:0 sc1
    buffer_load_dwordx4 v[52:55], v120, s[12:15], s50 offen offset:1024 sc1
    buffer_load_dwordx4 v[56:59], v120, s[12:15], s50 offen offset:2048 sc1
    buffer_load_dwordx4 v[60:63], v120, s[12:15], s50 offen offset:3072 sc1
    s_mov_b32 s20, s56
    s_and_b32 s21, s57, 0xffff
    s_mov_b32 s22, 0x100
    s_mov_b32 s23, 0x20000
    v_lshrrev_b32 v121, 5, v113
    s_lshl_b32 s50, s48, 6
    v_lshl_add_u32 v122, v121, 5, s50
    buffer_load_dwordx4 v[96:99], v122, s[20:23], 0 offen
    buffer_load_dwordx4 v[100:103], v122, s[20:23], 0 offen offset:16
    v_and_b32 v123, 31, v113
    s_lshl_b32 s49, s49, 5
    v_add_u32 v123, s49, v123
    v_mul_u32_u24 v124, 528, v123
    v_lshl_add_u32 v124, v121, 4, v124
    v_lshlrev_b32 v125, 2, v123
    v_add_u32 v125, 21344, v125
    s_mul_i32 s49, s24, 25088
    v_lshl_add_u32 v122, v123, 8, v122
    ds_read_b32 v126, v125
    s_waitcnt vmcnt(0) lgkmcnt(0)
    v_cvt_f32_u32 v126, v126
    v_lshlrev_b32 v64, 16, v96
    v_and_b32 v65, 0xffff0000, v96
    v_lshlrev_b32 v66, 16, v97
    v_and_b32 v67, 0xffff0000, v97
    v_lshlrev_b32 v68, 16, v98
    v_and_b32 v69, 0xffff0000, v98
    v_lshlrev_b32 v70, 16, v99
    v_and_b32 v71, 0xffff0000, v99
    v_lshlrev_b32 v72, 16, v100
    v_and_b32 v73, 0xffff0000, v100
    v_lshlrev_b32 v74, 16, v101
    v_and_b32 v75, 0xffff0000, v101
    v_lshlrev_b32 v76, 16, v102
    v_and_b32 v77, 0xffff0000, v102
    v_lshlrev_b32 v78, 16, v103
    v_and_b32 v79, 0xffff0000, v103
    v_mul_f32 v64, v126, v64
    v_mul_f32 v65, v126, v65
    v_mul_f32 v66, v126, v66
    v_mul_f32 v67, v126, v67
    v_mul_f32 v68, v126, v68
    v_mul_f32 v69, v126, v69
    v_mul_f32 v70, v126, v70
    v_mul_f32 v71, v126, v71
    v_mul_f32 v72, v126, v72
    v_mul_f32 v73, v126, v73
    v_mul_f32 v74, v126, v74
    v_mul_f32 v75, v126, v75
    v_mul_f32 v76, v126, v76
    v_mul_f32 v77, v126, v77
    v_mul_f32 v78, v126, v78
    v_mul_f32 v79, v126, v79
    s_barrier
    ds_read_b128 v[80:83], v124 offset:23600
    ds_read_b128 v[84:87], v124 offset:23632
    ds_read_b128 v[88:91], v124 offset:23664
    ds_read_b128 v[92:95], v124 offset:23696
    ds_read_b128 v[96:99], v124 offset:23728
    ds_read_b128 v[100:103], v124 offset:23760
    s_waitcnt lgkmcnt(5)
    v_mfma_f32_32x32x16_bf16 v[64:79], v[0:3], v[80:83], v[64:79]
    ds_read_b128 v[80:83], v124 offset:23792
    s_waitcnt lgkmcnt(5)
    v_mfma_f32_32x32x16_bf16 v[64:79], v[4:7], v[84:87], v[64:79]
    ds_read_b128 v[84:87], v124 offset:23824
    s_waitcnt lgkmcnt(5)
    v_mfma_f32_32x32x16_bf16 v[64:79], v[8:11], v[88:91], v[64:79]
    ds_read_b128 v[88:91], v124 offset:23856
    s_waitcnt lgkmcnt(5)
    v_mfma_f32_32x32x16_bf16 v[64:79], v[12:15], v[92:95], v[64:79]
    ds_read_b128 v[92:95], v124 offset:23888
    s_waitcnt lgkmcnt(5)
    v_mfma_f32_32x32x16_bf16 v[64:79], v[16:19], v[96:99], v[64:79]
    ds_read_b128 v[96:99], v124 offset:23920
    s_waitcnt lgkmcnt(5)
    v_mfma_f32_32x32x16_bf16 v[64:79], v[20:23], v[100:103], v[64:79]
    ds_read_b128 v[100:103], v124 offset:23952
    s_waitcnt lgkmcnt(5)
    v_mfma_f32_32x32x16_bf16 v[64:79], v[24:27], v[80:83], v[64:79]
    ds_read_b128 v[80:83], v124 offset:23984
    s_waitcnt lgkmcnt(5)
    v_mfma_f32_32x32x16_bf16 v[64:79], v[28:31], v[84:87], v[64:79]
    ds_read_b128 v[84:87], v124 offset:24016
    s_waitcnt lgkmcnt(5)
    v_mfma_f32_32x32x16_bf16 v[64:79], v[32:35], v[88:91], v[64:79]
    ds_read_b128 v[88:91], v124 offset:24048
    s_waitcnt lgkmcnt(5)
    v_mfma_f32_32x32x16_bf16 v[64:79], v[36:39], v[92:95], v[64:79]
    ds_read_b128 v[92:95], v124 offset:24080
    s_waitcnt lgkmcnt(5)
    v_mfma_f32_32x32x16_bf16 v[64:79], v[40:43], v[96:99], v[64:79]
    s_waitcnt lgkmcnt(4)
    v_mfma_f32_32x32x16_bf16 v[64:79], v[44:47], v[100:103], v[64:79]
    s_waitcnt lgkmcnt(3)
    v_mfma_f32_32x32x16_bf16 v[64:79], v[48:51], v[80:83], v[64:79]
    s_waitcnt lgkmcnt(2)
    v_mfma_f32_32x32x16_bf16 v[64:79], v[52:55], v[84:87], v[64:79]
    s_waitcnt lgkmcnt(1)
    v_mfma_f32_32x32x16_bf16 v[64:79], v[56:59], v[88:91], v[64:79]
    s_waitcnt lgkmcnt(0)
    v_mfma_f32_32x32x16_bf16 v[64:79], v[60:63], v[92:95], v[64:79]
    s_lshl_b32 s50, s25, 11
    s_add_u32 s50, s50, 76800
    v_and_b32 v125, 31, v113
    v_lshlrev_b32 v125, 6, v125
    v_lshl_add_u32 v125, v121, 5, v125
    v_add_u32 v125, s50, v125
    v_lshl_add_u32 v126, v113, 4, s50
    v_lshrrev_b32 v124, 2, v113
    s_lshr_b32 s50, s25, 2
    s_lshl_b32 s50, s50, 5
    v_add_u32 v124, s50, v124
    v_and_b32 v122, 3, v113
    v_cvt_pk_bf16_f32 v0, v64, v65
    v_cvt_pk_bf16_f32 v1, v66, v67
    v_cvt_pk_bf16_f32 v2, v68, v69
    v_cvt_pk_bf16_f32 v3, v70, v71
    v_cvt_pk_bf16_f32 v4, v72, v73
    v_cvt_pk_bf16_f32 v5, v74, v75
    v_cvt_pk_bf16_f32 v6, v76, v77
    v_cvt_pk_bf16_f32 v7, v78, v79
    ds_write_b128 v125, v[0:3]
    ds_write_b128 v125, v[4:7] offset:16
    ds_read_b128 v[8:11], v126
    ds_read_b128 v[12:15], v126 offset:1024
    v_lshlrev_b32 v122, 4, v122
    s_lshl_b32 s48, s48, 6
    v_lshl_add_u32 v122, v124, 8, v122
    s_add_u32 s49, s49, s48
    s_add_u32 s48, s49, 4096
    v_cmpx_gt_u32 vcc, 98, v124
    s_cbranch_execz main_end
    s_waitcnt lgkmcnt(1)
    buffer_store_dwordx4 v[8:11], v122, s[16:19], s49 offen nt
    v_cmpx_gt_u32 vcc, 82, v124
    s_cbranch_execz main_end
    s_waitcnt lgkmcnt(0)
    buffer_store_dwordx4 v[12:15], v122, s[16:19], s48 offen nt
main_end:
main_done:
    s_endpgm
    .p2align 6
lut_jobs:
    .long 0x0
    .long 0x0
    .long 0xd00090
    .long 0x0
    .long 0xb20091
    .long 0xbf
    .long 0xc00092
    .long 0x11cd
    .long 0xd10093
    .long 0x1415
    .long 0xd20094
    .long 0x149d
    .long 0x162600d3
    .long 0x1641
    .long 0x63300d4
    .long 0x0
    .long 0x0
    .long 0x0
    .long 0x0
    .long 0x0
    .long 0x0
    .long 0x0
    .long 0x0
    .long 0x0
    .long 0x1281
    .long 0x0
    .long 0x1286
    .long 0x0
    .long 0x128b
    .long 0x0
    .long 0x80
    .long 0x0
.section .rodata,"a"
.p2align 6
.amdhsa_kernel gather_scatter__edge_featured_mpnn_mpnn__graph_kernel
  .amdhsa_next_free_vgpr 128
  .amdhsa_next_free_sgpr 80
  .amdhsa_accum_offset 128
  .amdhsa_group_segment_fixed_size 0
  .amdhsa_kernarg_size 88
  .amdhsa_user_sgpr_count 2
  .amdhsa_user_sgpr_kernarg_segment_ptr 1
  .amdhsa_system_sgpr_workgroup_id_x 1
.end_amdhsa_kernel
```
